```python
import torch

def _softmax(x, axis=-1):
    return torch.softmax(x, dim=axis)
def _gelu(x):
    return torch.nn.functional.gelu(x, approximate="tanh")
def _silu(x):
    return torch.nn.functional.silu(x)
def _sigmoid(x):
    return torch.sigmoid(x)
def _layernorm(x, axis=-1, eps=1e-5):
    m = x.mean(dim=axis, keepdim=True)
    v = x.var(dim=axis, keepdim=True, unbiased=False)
    return (x - m) / torch.sqrt(v + eps)
def _scatter_add(tgt, idx, src, axis=0):
    return tgt.clone().index_add_(axis, idx, src)
def _segment_sum(src, seg, n):
    out = torch.zeros((n,) + src.shape[1:], dtype=src.dtype)
    return out.index_add_(0, seg, src)
def _pad(x, pw):
    flat = tuple(v for pair in reversed(pw) for v in pair)
    return torch.nn.functional.pad(x, flat)

kernel_name = 'parallel_sum__spectral_gfnet__dense_activation_gelu__prompt'

def setup_inputs():

    _w = (lambda a: (lambda t: t.to(torch.bfloat16) if t.is_floating_point() else t)(torch.as_tensor(a)))
    def _A_setup():
        B, S, D = 1, 2048, 448
        Df = D // 2 + 1
        return {
            "x": _w((lambda *s: torch.randn(*s, dtype=torch.bfloat16) * 0.05)(B, S, D)),
            "w_r": _w((lambda *s: torch.randn(*s, dtype=torch.bfloat16) * 0.8)(S, Df) * 0.02),
            "w_i": _w((lambda *s: torch.randn(*s, dtype=torch.bfloat16) * 0.8)(S, Df) * 0.02),
        }
    _A_in = _A_setup()

    def _B_setup():
        B, S, D, F = 1, 2048, 448, 1792
        return {
            "x": _w((lambda *s: torch.randn(*s, dtype=torch.bfloat16) * 0.05)(B, S, D)),
            "w1": _w((lambda *s: torch.randn(*s, dtype=torch.bfloat16) * 0.4)(D, F) * (D ** -0.5)),
            "b1": _w((lambda *s: torch.randn(*s, dtype=torch.bfloat16) * 12.8)(F) * 0.01),
            "w2": _w((lambda *s: torch.randn(*s, dtype=torch.bfloat16) * 0.2)(F, D) * (F ** -0.5)),
            "b2": _w((lambda *s: torch.randn(*s, dtype=torch.bfloat16) * 1.6)(D) * 0.01),
        }
    _B_in = _B_setup()

    return {
        "A_x": _A_in["x"],
        "A_w_r": _A_in["w_r"],
        "A_w_i": _A_in["w_i"],
        "B_x": _B_in["x"],
        "B_w1": _B_in["w1"],
        "B_b1": _B_in["b1"],
        "B_w2": _B_in["w2"],
        "B_b2": _B_in["b2"],
    }

def reference(A_x, A_w_r, A_w_i, B_x, B_w1, B_b1, B_w2, B_b2):
    def _A_ref(x, w_r, w_i):
        B, S, D = x.shape
        X = (lambda x, axes=(-2,-1): torch.fft.rfft2(x.float(), dim=axes))(x, axes=(-2, -1))
        W = w_r + 1j * w_i
        X = X * W
        y = (lambda x, s, axes=(-2,-1): torch.fft.irfft2(x, s=s, dim=axes).to(torch.bfloat16))(X, (S, D), axes=(-2, -1))
        return y

    def _B_ref(x, w1, b1, w2, b2):
        h = torch.einsum("bsd,df->bsf", x, w1) + b1
        h = _gelu(h)
        return torch.einsum("bsf,fd->bsd", h, w2) + b2

    x = A_x
    xn = _layernorm(x, axis=-1)
    return x + _A_ref(xn, A_w_r, A_w_i) + _B_ref(xn, B_w1, B_b1, B_w2, B_b2)
```

```asm
; @launch kernel=k1_kernel grid=(256,1,1) block=(512,1,1) lds=162816
; @launch kernel=k2_kernel grid=(256,1,1) block=(512,1,1) lds=131072
; @launch kernel=k3_kernel grid=(256,1,1) block=(512,1,1) lds=45056
.amdgcn_target "amdgcn-amd-amdhsa--gfx950"
.text
.globl k1_kernel
.p2align 8
.type k1_kernel,@function
k1_kernel:
    s_cmp_ge_u32 s2, 256
    s_cbranch_scc1 k1_kernel_end
    s_load_dwordx16 s[16:31], s[0:1], 0
    s_load_dwordx2 s[32:33], s[0:1], 64
    s_load_dwordx2 s[34:35], s[0:1], 80
    s_getpc_b64 s[36:37]
k1_kernel_pc:
    v_lshlrev_b32 v251, 7, v0
    v_min_u32 v251, code_end-k1_kernel_pc-4, v251
    global_load_dword v251, v251, s[36:37]
    v_lshrrev_b32 v2, 6, v0
    v_and_b32 v1, 63, v0
    v_readfirstlane_b32 s3, v2
    s_cmp_ge_u32 s2, 224
    s_cbranch_scc1 k1_kernel_misc
    s_and_b32 s69, s3, 3
    s_and_b32 s4, s2, 7
    s_lshr_b32 s5, s2, 3
    s_and_b32 s6, s5, 1
    s_bfe_u32 s12, s5, 0x10001
    s_lshr_b32 s13, s5, 2
    s_and_b32 s7, s4, 1
    s_mul_i32 s7, s7, 7
    s_add_u32 s7, s7, s13
    s_lshr_b32 s8, s4, 1
    s_lshl_b32 s8, s8, 1
    s_add_u32 s8, s8, s12
    s_lshl_b32 s8, s8, 2
    s_add_u32 s8, s8, s69
    v_lshlrev_b32 v6, 4, v1
    v_and_b32 v8, 31, v1
    v_lshrrev_b32 v7, 5, v1
    s_mov_b32 s15, 0x3b124925
    s_lshl_b32 s9, s69, 12
    s_add_u32 s9, s9, 143360
    s_lshl_b32 s63, s8, 1
    s_add_u32 s63, s63, s6
    s_mul_i32 s63, s63, 229376
    s_lshl_b32 s64, s7, 13
    s_add_u32 s63, s63, s64
    s_lshl_b32 s64, s6, 12
    s_add_u32 s63, s63, s64
    s_xor_b32 s64, s63, 4096
    s_lshl_b32 s62, s69, 8
    s_add_u32 s62, s62, 161792
    s_lshl_b32 s14, s7, 5
    v_add_u32 v2, s14, v8
    v_lshrrev_b32 v3, 1, v2
    v_and_b32 v4, 1, v2
    v_cmp_eq_u32 vcc, 1, v2
    v_mov_b32 v5, 224
    s_nop 0
    v_cndmask_b32 v3, v3, v5, vcc
    v_cndmask_b32 v4, v4, 0, vcc
    v_cvt_f32_u32 v3, v3
    v_cvt_f32_u32 v4, v4
    v_mul_f32 v4, 0x3e800000, v4
    v_mul_f32 v57, 0x3b124925, v3
    v_mul_f32 v58, 0x3b924925, v3
    v_mul_f32 v59, 0x3bdb6db7, v3
    v_mul_f32 v60, 0x3c124925, v3
    v_mul_f32 v61, 0x3c36db6e, v3
    v_mul_f32 v62, 0x3c5b6db7, v3
    v_mul_f32 v63, 0x3c800000, v3
    s_mul_i32 s10, s3, 3
    s_sub_u32 s11, s3, 4
    s_max_i32 s11, s11, 0
    s_add_u32 s10, s10, s11
    s_lshl_b32 s66, s10, 10
    s_lshl_b32 s10, s10, 4
    s_lshl_b32 s11, s13, 6
    s_add_u32 s10, s10, s11
    v_lshlrev_b32 v2, 3, v7
    v_add_u32 v2, s10, v2
    v_cvt_f32_u32 v2, v2
    v_mul_f32 v2, v2, v3
    v_mul_f32 v3, 0x41800000, v3
    s_mov_b32 s65, 0xc3e00000
    s_add_u32 s66, s66, 114688
    v_add_u32 v56, s66, v6
    v_mul_f32 v5, s15, v2
    v_floor_f32 v5, v5
    v_fma_f32 v5, v5, s65, v2
    v_fma_f32 v24, v5, s15, v4
    v_add_f32 v25, v24, v57
    v_add_f32 v26, v24, v58
    v_add_f32 v27, v24, v59
    v_add_f32 v28, v24, v60
    v_add_f32 v29, v24, v61
    v_add_f32 v30, v24, v62
    v_add_f32 v31, v24, v63
    v_cos_f32 v24, v24
    v_cos_f32 v25, v25
    v_cos_f32 v26, v26
    v_cos_f32 v27, v27
    v_cos_f32 v28, v28
    v_cos_f32 v29, v29
    v_cos_f32 v30, v30
    v_cos_f32 v31, v31
    v_add_f32 v2, v2, v3
    v_cvt_pk_bf16_f32 v40, v24, v25
    v_cvt_pk_bf16_f32 v41, v26, v27
    v_cvt_pk_bf16_f32 v42, v28, v29
    v_cvt_pk_bf16_f32 v43, v30, v31
    ds_write_b128 v56, v[40:43] offset:0
    v_mul_f32 v5, s15, v2
    v_floor_f32 v5, v5
    v_fma_f32 v5, v5, s65, v2
    v_fma_f32 v24, v5, s15, v4
    v_add_f32 v25, v24, v57
    v_add_f32 v26, v24, v58
    v_add_f32 v27, v24, v59
    v_add_f32 v28, v24, v60
    v_add_f32 v29, v24, v61
    v_add_f32 v30, v24, v62
    v_add_f32 v31, v24, v63
    v_cos_f32 v24, v24
    v_cos_f32 v25, v25
    v_cos_f32 v26, v26
    v_cos_f32 v27, v27
    v_cos_f32 v28, v28
    v_cos_f32 v29, v29
    v_cos_f32 v30, v30
    v_cos_f32 v31, v31
    v_add_f32 v2, v2, v3
    v_cvt_pk_bf16_f32 v44, v24, v25
    v_cvt_pk_bf16_f32 v45, v26, v27
    v_cvt_pk_bf16_f32 v46, v28, v29
    v_cvt_pk_bf16_f32 v47, v30, v31
    ds_write_b128 v56, v[44:47] offset:1024
    v_mul_f32 v5, s15, v2
    v_floor_f32 v5, v5
    v_fma_f32 v5, v5, s65, v2
    v_fma_f32 v24, v5, s15, v4
    v_add_f32 v25, v24, v57
    v_add_f32 v26, v24, v58
    v_add_f32 v27, v24, v59
    v_add_f32 v28, v24, v60
    v_add_f32 v29, v24, v61
    v_add_f32 v30, v24, v62
    v_add_f32 v31, v24, v63
    v_cos_f32 v24, v24
    v_cos_f32 v25, v25
    v_cos_f32 v26, v26
    v_cos_f32 v27, v27
    v_cos_f32 v28, v28
    v_cos_f32 v29, v29
    v_cos_f32 v30, v30
    v_cos_f32 v31, v31
    v_add_f32 v2, v2, v3
    v_cvt_pk_bf16_f32 v48, v24, v25
    v_cvt_pk_bf16_f32 v49, v26, v27
    v_cvt_pk_bf16_f32 v50, v28, v29
    v_cvt_pk_bf16_f32 v51, v30, v31
    ds_write_b128 v56, v[48:51] offset:2048
    s_cmp_ge_u32 s3, 4
    s_cbranch_scc1 k1_kernel_help
    s_setprio 3
    v_lshrrev_b32 v2, 3, v1
    v_and_b32 v3, 7, v1
    s_lshl_b32 s10, s6, 10
    s_add_u32 s10, s10, s8
    s_mul_i32 s52, s10, 896
    s_add_u32 s53, s52, 28672
    s_add_u32 s54, s52, 57344
    s_add_u32 s55, s52, 86016
    s_lshl_b32 s59, s13, 7
    v_bfe_u32 v4, v1, 2, 3
    v_mul_u32_u24 v19, 114688, v4
    v_and_b32 v4, 3, v1
    v_lshl_add_u32 v19, v4, 5, v19
    v_lshl_add_u32 v19, v7, 4, v19
    s_mov_b32 s48, 0x55555555
    s_mov_b32 s49, 0x55555555
    s_mov_b32 s50, 0x33333333
    s_mov_b32 s51, 0x33333333
    s_waitcnt lgkmcnt(0)
    s_mov_b32 s36, s16
    s_and_b32 s37, s17, 0xffff
    s_mov_b32 s38, 1835008
    s_mov_b32 s39, 0x00020000
    v_add_u32 v20, s59, v19
    buffer_load_dwordx4 v[40:43], v20, s[36:39], s52 offen
    buffer_load_dwordx4 v[44:47], v20, s[36:39], s53 offen
    buffer_load_dwordx4 v[48:51], v20, s[36:39], s54 offen
    buffer_load_dwordx4 v[52:55], v20, s[36:39], s55 offen
    s_add_u32 s59, s59, 128
    s_cmp_eq_u32 s59, 896
    s_cselect_b32 s59, 0, s59
    v_add_u32 v20, s59, v19
    buffer_load_dwordx4 v[56:59], v20, s[36:39], s52 offen
    buffer_load_dwordx4 v[60:63], v20, s[36:39], s53 offen
    buffer_load_dwordx4 v[64:67], v20, s[36:39], s54 offen
    buffer_load_dwordx4 v[68:71], v20, s[36:39], s55 offen
    s_add_u32 s59, s59, 128
    s_cmp_eq_u32 s59, 896
    s_cselect_b32 s59, 0, s59
    v_add_u32 v20, s59, v19
    buffer_load_dwordx4 v[72:75], v20, s[36:39], s52 offen
    buffer_load_dwordx4 v[76:79], v20, s[36:39], s53 offen
    buffer_load_dwordx4 v[80:83], v20, s[36:39], s54 offen
    buffer_load_dwordx4 v[84:87], v20, s[36:39], s55 offen
    s_add_u32 s59, s59, 128
    s_cmp_eq_u32 s59, 896
    s_cselect_b32 s59, 0, s59
    v_add_u32 v20, s59, v19
    buffer_load_dwordx4 v[88:91], v20, s[36:39], s52 offen
    buffer_load_dwordx4 v[92:95], v20, s[36:39], s53 offen
    buffer_load_dwordx4 v[96:99], v20, s[36:39], s54 offen
    buffer_load_dwordx4 v[100:103], v20, s[36:39], s55 offen
    s_add_u32 s59, s59, 128
    s_cmp_eq_u32 s59, 896
    s_cselect_b32 s59, 0, s59
    v_add_u32 v20, s59, v19
    buffer_load_dwordx4 v[104:107], v20, s[36:39], s52 offen
    buffer_load_dwordx4 v[108:111], v20, s[36:39], s53 offen
    buffer_load_dwordx4 v[112:115], v20, s[36:39], s54 offen
    buffer_load_dwordx4 v[116:119], v20, s[36:39], s55 offen
    s_add_u32 s59, s59, 128
    s_cmp_eq_u32 s59, 896
    s_cselect_b32 s59, 0, s59
    v_add_u32 v20, s59, v19
    buffer_load_dwordx4 v[120:123], v20, s[36:39], s52 offen
    buffer_load_dwordx4 v[124:127], v20, s[36:39], s53 offen
    buffer_load_dwordx4 v[128:131], v20, s[36:39], s54 offen
    buffer_load_dwordx4 v[132:135], v20, s[36:39], s55 offen
    s_add_u32 s59, s59, 128
    s_cmp_eq_u32 s59, 896
    s_cselect_b32 s59, 0, s59
    v_add_u32 v20, s59, v19
    buffer_load_dwordx4 v[136:139], v20, s[36:39], s52 offen
    buffer_load_dwordx4 v[140:143], v20, s[36:39], s53 offen
    buffer_load_dwordx4 v[144:147], v20, s[36:39], s54 offen
    buffer_load_dwordx4 v[148:151], v20, s[36:39], s55 offen
    s_add_u32 s59, s59, 128
    s_cmp_eq_u32 s59, 896
    s_cselect_b32 s59, 0, s59
    s_barrier
    s_mov_b32 s44, s34
    s_and_b32 s45, s35, 0xffff
    s_mov_b32 s46, 268435456
    s_mov_b32 s47, 0x00020000
    v_bfe_u32 v2, v1, 2, 2
    v_lshl_add_u32 v3, v7, 3, v2
    v_lshlrev_b32 v3, 7, v3
    v_bfe_u32 v4, v1, 3, 1
    v_lshl_add_u32 v3, v4, 6, v3
    v_bfe_u32 v4, v1, 4, 1
    v_lshl_add_u32 v3, v4, 5, v3
    v_and_b32 v4, 3, v1
    v_lshl_add_u32 v36, v4, 3, v3
    v_lshrrev_b32 v2, 2, v1
    v_xor_b32 v2, v2, v1
    v_and_b32 v2, 4, v2
    v_cmp_eq_u32 vcc, 0, v2
    v_mov_b32 v2, 0x3f803f80
    s_nop 0
    v_cndmask_b32 v12, 0, v2, vcc
    v_cndmask_b32 v13, 0, v2, vcc
    v_cndmask_b32 v14, 0, v2, vcc
    v_cndmask_b32 v15, 0, v2, vcc
    v_xor_b32 v37, 64, v36
    v_add_u32 v38, 57344, v36
    v_add_u32 v39, 57344, v37
    v_lshrrev_b32 v2, 3, v8
    v_lshlrev_b32 v2, 10, v2
    v_lshl_add_u32 v2, v8, 4, v2
    v_bfe_u32 v3, v8, 2, 1
    v_lshl_add_u32 v2, v3, 9, v2
    v_and_b32 v3, 3, v8
    v_lshl_add_u32 v2, v3, 2, v2
    v_add_u32 v246, s9, v2
    v_mov_b32 v238, 0
    v_mov_b32 v239, 0
    v_mov_b32 v242, 0
    v_mov_b32 v243, 0
    s_lshl_b32 s14, s7, 5
    v_add_u32 v2, s14, v8
    v_cmp_eq_u32 vcc, 0, v2
    v_mov_b32 v5, 0x43e0
    v_mov_b32 v237, 0
    v_cndmask_b32 v236, 0, v5, vcc
    v_add_u32 v18, 114688, v6
    v_lshlrev_b32 v247, 3, v8
    v_add_u32 v247, 159744, v247
    v_add_u32 v248, s9, v6
    v_add_u32 v249, -28672, v248
    v_lshlrev_b32 v244, 12, v8
    v_lshl_add_u32 v244, v7, 9, v244
    s_lshl_b32 s67, s7, 17
    s_lshl_b32 s68, s6, 11
    s_add_u32 s67, s67, s68
    s_lshl_b32 s68, s8, 4
    s_add_u32 s67, s67, s68
    s_add_u32 s67, s67, 14680064
    v_lshl_add_u32 v245, v7, 4, s62
    ds_read_b128 v[204:207], v18 offset:0
    ds_read_b128 v[208:211], v18 offset:1024
    ds_read_b128 v[212:215], v18 offset:2048
    ds_read_b128 v[216:219], v18 offset:3072
    s_waitcnt vmcnt(26)
    s_mov_b64 vcc, s[48:49]
    v_cndmask_b32_dpp v152, v44, v40, vcc quad_perm:[1,0,3,2] row_mask:0xf bank_mask:0xf
    v_cndmask_b32_dpp v153, v45, v41, vcc quad_perm:[1,0,3,2] row_mask:0xf bank_mask:0xf
    v_cndmask_b32_dpp v154, v46, v42, vcc quad_perm:[1,0,3,2] row_mask:0xf bank_mask:0xf
    v_cndmask_b32_dpp v155, v47, v43, vcc quad_perm:[1,0,3,2] row_mask:0xf bank_mask:0xf
    s_waitcnt vmcnt(24)
    v_cndmask_b32_dpp v160, v52, v48, vcc quad_perm:[1,0,3,2] row_mask:0xf bank_mask:0xf
    v_cndmask_b32_dpp v161, v53, v49, vcc quad_perm:[1,0,3,2] row_mask:0xf bank_mask:0xf
    v_cndmask_b32_dpp v162, v54, v50, vcc quad_perm:[1,0,3,2] row_mask:0xf bank_mask:0xf
    v_cndmask_b32_dpp v163, v55, v51, vcc quad_perm:[1,0,3,2] row_mask:0xf bank_mask:0xf
    s_not_b64 vcc, vcc
    v_cndmask_b32_dpp v156, v40, v44, vcc quad_perm:[1,0,3,2] row_mask:0xf bank_mask:0xf
    v_cndmask_b32_dpp v157, v41, v45, vcc quad_perm:[1,0,3,2] row_mask:0xf bank_mask:0xf
    v_cndmask_b32_dpp v158, v42, v46, vcc quad_perm:[1,0,3,2] row_mask:0xf bank_mask:0xf
    v_cndmask_b32_dpp v159, v43, v47, vcc quad_perm:[1,0,3,2] row_mask:0xf bank_mask:0xf
    v_cndmask_b32_dpp v164, v48, v52, vcc quad_perm:[1,0,3,2] row_mask:0xf bank_mask:0xf
    v_cndmask_b32_dpp v165, v49, v53, vcc quad_perm:[1,0,3,2] row_mask:0xf bank_mask:0xf
    v_cndmask_b32_dpp v166, v50, v54, vcc quad_perm:[1,0,3,2] row_mask:0xf bank_mask:0xf
    v_cndmask_b32_dpp v167, v51, v55, vcc quad_perm:[1,0,3,2] row_mask:0xf bank_mask:0xf
    s_mov_b64 vcc, s[50:51]
    v_cndmask_b32_dpp v40, v160, v152, vcc quad_perm:[2,3,0,1] row_mask:0xf bank_mask:0xf
    v_cndmask_b32_dpp v41, v161, v153, vcc quad_perm:[2,3,0,1] row_mask:0xf bank_mask:0xf
    v_cndmask_b32_dpp v42, v162, v154, vcc quad_perm:[2,3,0,1] row_mask:0xf bank_mask:0xf
    v_cndmask_b32_dpp v43, v163, v155, vcc quad_perm:[2,3,0,1] row_mask:0xf bank_mask:0xf
    v_cndmask_b32_dpp v44, v164, v156, vcc quad_perm:[2,3,0,1] row_mask:0xf bank_mask:0xf
    v_cndmask_b32_dpp v45, v165, v157, vcc quad_perm:[2,3,0,1] row_mask:0xf bank_mask:0xf
    v_cndmask_b32_dpp v46, v166, v158, vcc quad_perm:[2,3,0,1] row_mask:0xf bank_mask:0xf
    v_cndmask_b32_dpp v47, v167, v159, vcc quad_perm:[2,3,0,1] row_mask:0xf bank_mask:0xf
    s_not_b64 vcc, vcc
    v_cndmask_b32_dpp v48, v152, v160, vcc quad_perm:[2,3,0,1] row_mask:0xf bank_mask:0xf
    v_cndmask_b32_dpp v49, v153, v161, vcc quad_perm:[2,3,0,1] row_mask:0xf bank_mask:0xf
    v_cndmask_b32_dpp v50, v154, v162, vcc quad_perm:[2,3,0,1] row_mask:0xf bank_mask:0xf
    v_cndmask_b32_dpp v51, v155, v163, vcc quad_perm:[2,3,0,1] row_mask:0xf bank_mask:0xf
    v_cndmask_b32_dpp v52, v156, v164, vcc quad_perm:[2,3,0,1] row_mask:0xf bank_mask:0xf
    v_cndmask_b32_dpp v53, v157, v165, vcc quad_perm:[2,3,0,1] row_mask:0xf bank_mask:0xf
    v_cndmask_b32_dpp v54, v158, v166, vcc quad_perm:[2,3,0,1] row_mask:0xf bank_mask:0xf
    v_cndmask_b32_dpp v55, v159, v167, vcc quad_perm:[2,3,0,1] row_mask:0xf bank_mask:0xf
    v_mfma_f32_32x32x16_bf16 v[184:199], v[40:43], v[40:43], 0
    s_waitcnt vmcnt(22)
    s_mov_b64 vcc, s[48:49]
    v_cndmask_b32_dpp v152, v60, v56, vcc quad_perm:[1,0,3,2] row_mask:0xf bank_mask:0xf
    v_cndmask_b32_dpp v153, v61, v57, vcc quad_perm:[1,0,3,2] row_mask:0xf bank_mask:0xf
    v_cndmask_b32_dpp v154, v62, v58, vcc quad_perm:[1,0,3,2] row_mask:0xf bank_mask:0xf
    v_mfma_f32_16x16x32_bf16 v[200:203], v[12:15], v[40:43], 0
    v_cndmask_b32_dpp v155, v63, v59, vcc quad_perm:[1,0,3,2] row_mask:0xf bank_mask:0xf
    s_waitcnt lgkmcnt(3)
    v_mfma_f32_32x32x16_bf16 v[168:183], v[40:43], v[204:207], 0
    ds_read_b128 v[220:223], v18 offset:4096
    s_waitcnt vmcnt(20)
    v_cndmask_b32_dpp v160, v68, v64, vcc quad_perm:[1,0,3,2] row_mask:0xf bank_mask:0xf
    v_cndmask_b32_dpp v161, v69, v65, vcc quad_perm:[1,0,3,2] row_mask:0xf bank_mask:0xf
    v_cndmask_b32_dpp v162, v70, v66, vcc quad_perm:[1,0,3,2] row_mask:0xf bank_mask:0xf
    v_cndmask_b32_dpp v163, v71, v67, vcc quad_perm:[1,0,3,2] row_mask:0xf bank_mask:0xf
    v_mfma_f32_32x32x16_bf16 v[184:199], v[44:47], v[44:47], v[184:199]
    s_not_b64 vcc, vcc
    v_cndmask_b32_dpp v156, v56, v60, vcc quad_perm:[1,0,3,2] row_mask:0xf bank_mask:0xf
    v_cndmask_b32_dpp v157, v57, v61, vcc quad_perm:[1,0,3,2] row_mask:0xf bank_mask:0xf
    v_cndmask_b32_dpp v158, v58, v62, vcc quad_perm:[1,0,3,2] row_mask:0xf bank_mask:0xf
    v_mfma_f32_16x16x32_bf16 v[200:203], v[12:15], v[44:47], v[200:203]
    v_cndmask_b32_dpp v159, v59, v63, vcc quad_perm:[1,0,3,2] row_mask:0xf bank_mask:0xf
    s_waitcnt lgkmcnt(3)
    v_mfma_f32_32x32x16_bf16 v[168:183], v[44:47], v[208:211], v[168:183]
    ds_read_b128 v[224:227], v18 offset:5120
    v_cndmask_b32_dpp v164, v64, v68, vcc quad_perm:[1,0,3,2] row_mask:0xf bank_mask:0xf
    v_cndmask_b32_dpp v165, v65, v69, vcc quad_perm:[1,0,3,2] row_mask:0xf bank_mask:0xf
    v_cndmask_b32_dpp v166, v66, v70, vcc quad_perm:[1,0,3,2] row_mask:0xf bank_mask:0xf
    v_cndmask_b32_dpp v167, v67, v71, vcc quad_perm:[1,0,3,2] row_mask:0xf bank_mask:0xf
    v_mfma_f32_32x32x16_bf16 v[184:199], v[48:51], v[48:51], v[184:199]
    s_mov_b64 vcc, s[50:51]
    v_cndmask_b32_dpp v56, v160, v152, vcc quad_perm:[2,3,0,1] row_mask:0xf bank_mask:0xf
    v_cndmask_b32_dpp v57, v161, v153, vcc quad_perm:[2,3,0,1] row_mask:0xf bank_mask:0xf
    v_cndmask_b32_dpp v58, v162, v154, vcc quad_perm:[2,3,0,1] row_mask:0xf bank_mask:0xf
    v_mfma_f32_16x16x32_bf16 v[200:203], v[12:15], v[48:51], v[200:203]
    v_cndmask_b32_dpp v59, v163, v155, vcc quad_perm:[2,3,0,1] row_mask:0xf bank_mask:0xf
    s_waitcnt lgkmcnt(3)
    v_mfma_f32_32x32x16_bf16 v[168:183], v[48:51], v[212:215], v[168:183]
    ds_read_b128 v[228:231], v18 offset:6144
    v_cndmask_b32_dpp v60, v164, v156, vcc quad_perm:[2,3,0,1] row_mask:0xf bank_mask:0xf
    v_cndmask_b32_dpp v61, v165, v157, vcc quad_perm:[2,3,0,1] row_mask:0xf bank_mask:0xf
    v_cndmask_b32_dpp v62, v166, v158, vcc quad_perm:[2,3,0,1] row_mask:0xf bank_mask:0xf
    v_cndmask_b32_dpp v63, v167, v159, vcc quad_perm:[2,3,0,1] row_mask:0xf bank_mask:0xf
    v_mfma_f32_32x32x16_bf16 v[184:199], v[52:55], v[52:55], v[184:199]
    s_not_b64 vcc, vcc
    v_cndmask_b32_dpp v64, v152, v160, vcc quad_perm:[2,3,0,1] row_mask:0xf bank_mask:0xf
    v_cndmask_b32_dpp v65, v153, v161, vcc quad_perm:[2,3,0,1] row_mask:0xf bank_mask:0xf
    v_cndmask_b32_dpp v66, v154, v162, vcc quad_perm:[2,3,0,1] row_mask:0xf bank_mask:0xf
    v_mfma_f32_16x16x32_bf16 v[200:203], v[12:15], v[52:55], v[200:203]
    v_cndmask_b32_dpp v67, v155, v163, vcc quad_perm:[2,3,0,1] row_mask:0xf bank_mask:0xf
    s_waitcnt lgkmcnt(3)
    v_mfma_f32_32x32x16_bf16 v[168:183], v[52:55], v[216:219], v[168:183]
    ds_read_b128 v[232:235], v18 offset:7168
    v_cndmask_b32_dpp v68, v156, v164, vcc quad_perm:[2,3,0,1] row_mask:0xf bank_mask:0xf
    v_cndmask_b32_dpp v69, v157, v165, vcc quad_perm:[2,3,0,1] row_mask:0xf bank_mask:0xf
    v_cndmask_b32_dpp v70, v158, v166, vcc quad_perm:[2,3,0,1] row_mask:0xf bank_mask:0xf
    v_cndmask_b32_dpp v71, v159, v167, vcc quad_perm:[2,3,0,1] row_mask:0xf bank_mask:0xf
    v_mfma_f32_32x32x16_bf16 v[184:199], v[56:59], v[56:59], v[184:199]
    s_waitcnt vmcnt(18)
    s_mov_b64 vcc, s[48:49]
    v_cndmask_b32_dpp v152, v76, v72, vcc quad_perm:[1,0,3,2] row_mask:0xf bank_mask:0xf
    v_cndmask_b32_dpp v153, v77, v73, vcc quad_perm:[1,0,3,2] row_mask:0xf bank_mask:0xf
    v_cndmask_b32_dpp v154, v78, v74, vcc quad_perm:[1,0,3,2] row_mask:0xf bank_mask:0xf
    v_mfma_f32_16x16x32_bf16 v[200:203], v[12:15], v[56:59], v[200:203]
    v_cndmask_b32_dpp v155, v79, v75, vcc quad_perm:[1,0,3,2] row_mask:0xf bank_mask:0xf
    s_waitcnt lgkmcnt(3)
    v_mfma_f32_32x32x16_bf16 v[168:183], v[56:59], v[220:223], v[168:183]
    ds_read_b128 v[204:207], v18 offset:8192
    s_waitcnt vmcnt(16)
    v_cndmask_b32_dpp v160, v84, v80, vcc quad_perm:[1,0,3,2] row_mask:0xf bank_mask:0xf
    v_cndmask_b32_dpp v161, v85, v81, vcc quad_perm:[1,0,3,2] row_mask:0xf bank_mask:0xf
    v_cndmask_b32_dpp v162, v86, v82, vcc quad_perm:[1,0,3,2] row_mask:0xf bank_mask:0xf
    v_cndmask_b32_dpp v163, v87, v83, vcc quad_perm:[1,0,3,2] row_mask:0xf bank_mask:0xf
    v_mfma_f32_32x32x16_bf16 v[184:199], v[60:63], v[60:63], v[184:199]
    s_not_b64 vcc, vcc
    v_cndmask_b32_dpp v156, v72, v76, vcc quad_perm:[1,0,3,2] row_mask:0xf bank_mask:0xf
    v_cndmask_b32_dpp v157, v73, v77, vcc quad_perm:[1,0,3,2] row_mask:0xf bank_mask:0xf
    v_cndmask_b32_dpp v158, v74, v78, vcc quad_perm:[1,0,3,2] row_mask:0xf bank_mask:0xf
    v_mfma_f32_16x16x32_bf16 v[200:203], v[12:15], v[60:63], v[200:203]
    v_cndmask_b32_dpp v159, v75, v79, vcc quad_perm:[1,0,3,2] row_mask:0xf bank_mask:0xf
    s_waitcnt lgkmcnt(3)
    v_mfma_f32_32x32x16_bf16 v[168:183], v[60:63], v[224:227], v[168:183]
    ds_read_b128 v[208:211], v18 offset:9216
    v_cndmask_b32_dpp v164, v80, v84, vcc quad_perm:[1,0,3,2] row_mask:0xf bank_mask:0xf
    v_cndmask_b32_dpp v165, v81, v85, vcc quad_perm:[1,0,3,2] row_mask:0xf bank_mask:0xf
    v_cndmask_b32_dpp v166, v82, v86, vcc quad_perm:[1,0,3,2] row_mask:0xf bank_mask:0xf
    v_cndmask_b32_dpp v167, v83, v87, vcc quad_perm:[1,0,3,2] row_mask:0xf bank_mask:0xf
    v_mfma_f32_32x32x16_bf16 v[184:199], v[64:67], v[64:67], v[184:199]
    s_mov_b64 vcc, s[50:51]
    v_cndmask_b32_dpp v72, v160, v152, vcc quad_perm:[2,3,0,1] row_mask:0xf bank_mask:0xf
    v_cndmask_b32_dpp v73, v161, v153, vcc quad_perm:[2,3,0,1] row_mask:0xf bank_mask:0xf
    v_cndmask_b32_dpp v74, v162, v154, vcc quad_perm:[2,3,0,1] row_mask:0xf bank_mask:0xf
    v_mfma_f32_16x16x32_bf16 v[200:203], v[12:15], v[64:67], v[200:203]
    v_cndmask_b32_dpp v75, v163, v155, vcc quad_perm:[2,3,0,1] row_mask:0xf bank_mask:0xf
    s_waitcnt lgkmcnt(3)
    v_mfma_f32_32x32x16_bf16 v[168:183], v[64:67], v[228:231], v[168:183]
    ds_read_b128 v[212:215], v18 offset:10240
    v_cndmask_b32_dpp v76, v164, v156, vcc quad_perm:[2,3,0,1] row_mask:0xf bank_mask:0xf
    v_cndmask_b32_dpp v77, v165, v157, vcc quad_perm:[2,3,0,1] row_mask:0xf bank_mask:0xf
    v_cndmask_b32_dpp v78, v166, v158, vcc quad_perm:[2,3,0,1] row_mask:0xf bank_mask:0xf
    v_cndmask_b32_dpp v79, v167, v159, vcc quad_perm:[2,3,0,1] row_mask:0xf bank_mask:0xf
    v_mfma_f32_32x32x16_bf16 v[184:199], v[68:71], v[68:71], v[184:199]
    s_not_b64 vcc, vcc
    v_cndmask_b32_dpp v80, v152, v160, vcc quad_perm:[2,3,0,1] row_mask:0xf bank_mask:0xf
    v_cndmask_b32_dpp v81, v153, v161, vcc quad_perm:[2,3,0,1] row_mask:0xf bank_mask:0xf
    v_cndmask_b32_dpp v82, v154, v162, vcc quad_perm:[2,3,0,1] row_mask:0xf bank_mask:0xf
    v_mfma_f32_16x16x32_bf16 v[200:203], v[12:15], v[68:71], v[200:203]
    v_cndmask_b32_dpp v83, v155, v163, vcc quad_perm:[2,3,0,1] row_mask:0xf bank_mask:0xf
    s_waitcnt lgkmcnt(3)
    v_mfma_f32_32x32x16_bf16 v[168:183], v[68:71], v[232:235], v[168:183]
    ds_read_b128 v[216:219], v18 offset:11264
    v_cndmask_b32_dpp v84, v156, v164, vcc quad_perm:[2,3,0,1] row_mask:0xf bank_mask:0xf
    v_cndmask_b32_dpp v85, v157, v165, vcc quad_perm:[2,3,0,1] row_mask:0xf bank_mask:0xf
    v_cndmask_b32_dpp v86, v158, v166, vcc quad_perm:[2,3,0,1] row_mask:0xf bank_mask:0xf
    v_cndmask_b32_dpp v87, v159, v167, vcc quad_perm:[2,3,0,1] row_mask:0xf bank_mask:0xf
    v_mfma_f32_32x32x16_bf16 v[184:199], v[72:75], v[72:75], v[184:199]
    s_waitcnt vmcnt(14)
    s_mov_b64 vcc, s[48:49]
    v_cndmask_b32_dpp v152, v92, v88, vcc quad_perm:[1,0,3,2] row_mask:0xf bank_mask:0xf
    v_cndmask_b32_dpp v153, v93, v89, vcc quad_perm:[1,0,3,2] row_mask:0xf bank_mask:0xf
    v_cndmask_b32_dpp v154, v94, v90, vcc quad_perm:[1,0,3,2] row_mask:0xf bank_mask:0xf
    v_mfma_f32_16x16x32_bf16 v[200:203], v[12:15], v[72:75], v[200:203]
    v_cndmask_b32_dpp v155, v95, v91, vcc quad_perm:[1,0,3,2] row_mask:0xf bank_mask:0xf
    s_waitcnt lgkmcnt(3)
    v_mfma_f32_32x32x16_bf16 v[168:183], v[72:75], v[204:207], v[168:183]
    ds_read_b128 v[220:223], v18 offset:12288
    s_waitcnt vmcnt(12)
    v_cndmask_b32_dpp v160, v100, v96, vcc quad_perm:[1,0,3,2] row_mask:0xf bank_mask:0xf
    v_cndmask_b32_dpp v161, v101, v97, vcc quad_perm:[1,0,3,2] row_mask:0xf bank_mask:0xf
    v_cndmask_b32_dpp v162, v102, v98, vcc quad_perm:[1,0,3,2] row_mask:0xf bank_mask:0xf
    v_cndmask_b32_dpp v163, v103, v99, vcc quad_perm:[1,0,3,2] row_mask:0xf bank_mask:0xf
    v_mfma_f32_32x32x16_bf16 v[184:199], v[76:79], v[76:79], v[184:199]
    s_not_b64 vcc, vcc
    v_cndmask_b32_dpp v156, v88, v92, vcc quad_perm:[1,0,3,2] row_mask:0xf bank_mask:0xf
    v_cndmask_b32_dpp v157, v89, v93, vcc quad_perm:[1,0,3,2] row_mask:0xf bank_mask:0xf
    v_cndmask_b32_dpp v158, v90, v94, vcc quad_perm:[1,0,3,2] row_mask:0xf bank_mask:0xf
    v_mfma_f32_16x16x32_bf16 v[200:203], v[12:15], v[76:79], v[200:203]
    v_cndmask_b32_dpp v159, v91, v95, vcc quad_perm:[1,0,3,2] row_mask:0xf bank_mask:0xf
    s_waitcnt lgkmcnt(3)
    v_mfma_f32_32x32x16_bf16 v[168:183], v[76:79], v[208:211], v[168:183]
    ds_read_b128 v[224:227], v18 offset:13312
    v_cndmask_b32_dpp v164, v96, v100, vcc quad_perm:[1,0,3,2] row_mask:0xf bank_mask:0xf
    v_cndmask_b32_dpp v165, v97, v101, vcc quad_perm:[1,0,3,2] row_mask:0xf bank_mask:0xf
    v_cndmask_b32_dpp v166, v98, v102, vcc quad_perm:[1,0,3,2] row_mask:0xf bank_mask:0xf
    v_cndmask_b32_dpp v167, v99, v103, vcc quad_perm:[1,0,3,2] row_mask:0xf bank_mask:0xf
    v_mfma_f32_32x32x16_bf16 v[184:199], v[80:83], v[80:83], v[184:199]
    s_mov_b64 vcc, s[50:51]
    v_cndmask_b32_dpp v88, v160, v152, vcc quad_perm:[2,3,0,1] row_mask:0xf bank_mask:0xf
    v_cndmask_b32_dpp v89, v161, v153, vcc quad_perm:[2,3,0,1] row_mask:0xf bank_mask:0xf
    v_cndmask_b32_dpp v90, v162, v154, vcc quad_perm:[2,3,0,1] row_mask:0xf bank_mask:0xf
    v_mfma_f32_16x16x32_bf16 v[200:203], v[12:15], v[80:83], v[200:203]
    v_cndmask_b32_dpp v91, v163, v155, vcc quad_perm:[2,3,0,1] row_mask:0xf bank_mask:0xf
    s_waitcnt lgkmcnt(3)
    v_mfma_f32_32x32x16_bf16 v[168:183], v[80:83], v[212:215], v[168:183]
    ds_read_b128 v[228:231], v18 offset:14336
    v_cndmask_b32_dpp v92, v164, v156, vcc quad_perm:[2,3,0,1] row_mask:0xf bank_mask:0xf
    v_cndmask_b32_dpp v93, v165, v157, vcc quad_perm:[2,3,0,1] row_mask:0xf bank_mask:0xf
    v_cndmask_b32_dpp v94, v166, v158, vcc quad_perm:[2,3,0,1] row_mask:0xf bank_mask:0xf
    v_cndmask_b32_dpp v95, v167, v159, vcc quad_perm:[2,3,0,1] row_mask:0xf bank_mask:0xf
    v_mfma_f32_32x32x16_bf16 v[184:199], v[84:87], v[84:87], v[184:199]
    s_not_b64 vcc, vcc
    v_cndmask_b32_dpp v96, v152, v160, vcc quad_perm:[2,3,0,1] row_mask:0xf bank_mask:0xf
    v_cndmask_b32_dpp v97, v153, v161, vcc quad_perm:[2,3,0,1] row_mask:0xf bank_mask:0xf
    v_cndmask_b32_dpp v98, v154, v162, vcc quad_perm:[2,3,0,1] row_mask:0xf bank_mask:0xf
    v_mfma_f32_16x16x32_bf16 v[200:203], v[12:15], v[84:87], v[200:203]
    v_cndmask_b32_dpp v99, v155, v163, vcc quad_perm:[2,3,0,1] row_mask:0xf bank_mask:0xf
    s_waitcnt lgkmcnt(3)
    v_mfma_f32_32x32x16_bf16 v[168:183], v[84:87], v[216:219], v[168:183]
    ds_read_b128 v[232:235], v18 offset:15360
    v_cndmask_b32_dpp v100, v156, v164, vcc quad_perm:[2,3,0,1] row_mask:0xf bank_mask:0xf
    v_cndmask_b32_dpp v101, v157, v165, vcc quad_perm:[2,3,0,1] row_mask:0xf bank_mask:0xf
    v_cndmask_b32_dpp v102, v158, v166, vcc quad_perm:[2,3,0,1] row_mask:0xf bank_mask:0xf
    v_cndmask_b32_dpp v103, v159, v167, vcc quad_perm:[2,3,0,1] row_mask:0xf bank_mask:0xf
    v_mfma_f32_32x32x16_bf16 v[184:199], v[88:91], v[88:91], v[184:199]
    s_waitcnt vmcnt(10)
    s_mov_b64 vcc, s[48:49]
    v_cndmask_b32_dpp v152, v108, v104, vcc quad_perm:[1,0,3,2] row_mask:0xf bank_mask:0xf
    v_cndmask_b32_dpp v153, v109, v105, vcc quad_perm:[1,0,3,2] row_mask:0xf bank_mask:0xf
    v_cndmask_b32_dpp v154, v110, v106, vcc quad_perm:[1,0,3,2] row_mask:0xf bank_mask:0xf
    v_mfma_f32_16x16x32_bf16 v[200:203], v[12:15], v[88:91], v[200:203]
    v_cndmask_b32_dpp v155, v111, v107, vcc quad_perm:[1,0,3,2] row_mask:0xf bank_mask:0xf
    s_waitcnt lgkmcnt(3)
    v_mfma_f32_32x32x16_bf16 v[168:183], v[88:91], v[220:223], v[168:183]
    ds_read_b128 v[204:207], v18 offset:16384
    s_waitcnt vmcnt(8)
    v_cndmask_b32_dpp v160, v116, v112, vcc quad_perm:[1,0,3,2] row_mask:0xf bank_mask:0xf
    v_cndmask_b32_dpp v161, v117, v113, vcc quad_perm:[1,0,3,2] row_mask:0xf bank_mask:0xf
    v_cndmask_b32_dpp v162, v118, v114, vcc quad_perm:[1,0,3,2] row_mask:0xf bank_mask:0xf
    v_cndmask_b32_dpp v163, v119, v115, vcc quad_perm:[1,0,3,2] row_mask:0xf bank_mask:0xf
    v_mfma_f32_32x32x16_bf16 v[184:199], v[92:95], v[92:95], v[184:199]
    s_not_b64 vcc, vcc
    v_cndmask_b32_dpp v156, v104, v108, vcc quad_perm:[1,0,3,2] row_mask:0xf bank_mask:0xf
    v_cndmask_b32_dpp v157, v105, v109, vcc quad_perm:[1,0,3,2] row_mask:0xf bank_mask:0xf
    v_cndmask_b32_dpp v158, v106, v110, vcc quad_perm:[1,0,3,2] row_mask:0xf bank_mask:0xf
    v_mfma_f32_16x16x32_bf16 v[200:203], v[12:15], v[92:95], v[200:203]
    v_cndmask_b32_dpp v159, v107, v111, vcc quad_perm:[1,0,3,2] row_mask:0xf bank_mask:0xf
    s_waitcnt lgkmcnt(3)
    v_mfma_f32_32x32x16_bf16 v[168:183], v[92:95], v[224:227], v[168:183]
    ds_read_b128 v[208:211], v18 offset:17408
    v_cndmask_b32_dpp v164, v112, v116, vcc quad_perm:[1,0,3,2] row_mask:0xf bank_mask:0xf
    v_cndmask_b32_dpp v165, v113, v117, vcc quad_perm:[1,0,3,2] row_mask:0xf bank_mask:0xf
    v_cndmask_b32_dpp v166, v114, v118, vcc quad_perm:[1,0,3,2] row_mask:0xf bank_mask:0xf
    v_cndmask_b32_dpp v167, v115, v119, vcc quad_perm:[1,0,3,2] row_mask:0xf bank_mask:0xf
    v_mfma_f32_32x32x16_bf16 v[184:199], v[96:99], v[96:99], v[184:199]
    s_mov_b64 vcc, s[50:51]
    v_cndmask_b32_dpp v104, v160, v152, vcc quad_perm:[2,3,0,1] row_mask:0xf bank_mask:0xf
    v_cndmask_b32_dpp v105, v161, v153, vcc quad_perm:[2,3,0,1] row_mask:0xf bank_mask:0xf
    v_cndmask_b32_dpp v106, v162, v154, vcc quad_perm:[2,3,0,1] row_mask:0xf bank_mask:0xf
    v_mfma_f32_16x16x32_bf16 v[200:203], v[12:15], v[96:99], v[200:203]
    v_cndmask_b32_dpp v107, v163, v155, vcc quad_perm:[2,3,0,1] row_mask:0xf bank_mask:0xf
    s_waitcnt lgkmcnt(3)
    v_mfma_f32_32x32x16_bf16 v[168:183], v[96:99], v[228:231], v[168:183]
    ds_read_b128 v[212:215], v18 offset:18432
    v_cndmask_b32_dpp v108, v164, v156, vcc quad_perm:[2,3,0,1] row_mask:0xf bank_mask:0xf
    v_cndmask_b32_dpp v109, v165, v157, vcc quad_perm:[2,3,0,1] row_mask:0xf bank_mask:0xf
    v_cndmask_b32_dpp v110, v166, v158, vcc quad_perm:[2,3,0,1] row_mask:0xf bank_mask:0xf
    v_cndmask_b32_dpp v111, v167, v159, vcc quad_perm:[2,3,0,1] row_mask:0xf bank_mask:0xf
    v_mfma_f32_32x32x16_bf16 v[184:199], v[100:103], v[100:103], v[184:199]
    s_not_b64 vcc, vcc
    v_cndmask_b32_dpp v112, v152, v160, vcc quad_perm:[2,3,0,1] row_mask:0xf bank_mask:0xf
    v_cndmask_b32_dpp v113, v153, v161, vcc quad_perm:[2,3,0,1] row_mask:0xf bank_mask:0xf
    v_cndmask_b32_dpp v114, v154, v162, vcc quad_perm:[2,3,0,1] row_mask:0xf bank_mask:0xf
    v_mfma_f32_16x16x32_bf16 v[200:203], v[12:15], v[100:103], v[200:203]
    v_cndmask_b32_dpp v115, v155, v163, vcc quad_perm:[2,3,0,1] row_mask:0xf bank_mask:0xf
    s_waitcnt lgkmcnt(3)
    v_mfma_f32_32x32x16_bf16 v[168:183], v[100:103], v[232:235], v[168:183]
    ds_read_b128 v[216:219], v18 offset:19456
    v_cndmask_b32_dpp v116, v156, v164, vcc quad_perm:[2,3,0,1] row_mask:0xf bank_mask:0xf
    v_cndmask_b32_dpp v117, v157, v165, vcc quad_perm:[2,3,0,1] row_mask:0xf bank_mask:0xf
    v_cndmask_b32_dpp v118, v158, v166, vcc quad_perm:[2,3,0,1] row_mask:0xf bank_mask:0xf
    v_cndmask_b32_dpp v119, v159, v167, vcc quad_perm:[2,3,0,1] row_mask:0xf bank_mask:0xf
    v_mfma_f32_32x32x16_bf16 v[184:199], v[104:107], v[104:107], v[184:199]
    s_waitcnt vmcnt(6)
    s_mov_b64 vcc, s[48:49]
    v_cndmask_b32_dpp v152, v124, v120, vcc quad_perm:[1,0,3,2] row_mask:0xf bank_mask:0xf
    v_cndmask_b32_dpp v153, v125, v121, vcc quad_perm:[1,0,3,2] row_mask:0xf bank_mask:0xf
    v_cndmask_b32_dpp v154, v126, v122, vcc quad_perm:[1,0,3,2] row_mask:0xf bank_mask:0xf
    v_mfma_f32_16x16x32_bf16 v[200:203], v[12:15], v[104:107], v[200:203]
    v_cndmask_b32_dpp v155, v127, v123, vcc quad_perm:[1,0,3,2] row_mask:0xf bank_mask:0xf
    s_waitcnt lgkmcnt(3)
    v_mfma_f32_32x32x16_bf16 v[168:183], v[104:107], v[204:207], v[168:183]
    ds_read_b128 v[220:223], v18 offset:20480
    s_waitcnt vmcnt(4)
    v_cndmask_b32_dpp v160, v132, v128, vcc quad_perm:[1,0,3,2] row_mask:0xf bank_mask:0xf
    v_cndmask_b32_dpp v161, v133, v129, vcc quad_perm:[1,0,3,2] row_mask:0xf bank_mask:0xf
    v_cndmask_b32_dpp v162, v134, v130, vcc quad_perm:[1,0,3,2] row_mask:0xf bank_mask:0xf
    v_cndmask_b32_dpp v163, v135, v131, vcc quad_perm:[1,0,3,2] row_mask:0xf bank_mask:0xf
    v_mfma_f32_32x32x16_bf16 v[184:199], v[108:111], v[108:111], v[184:199]
    s_not_b64 vcc, vcc
    v_cndmask_b32_dpp v156, v120, v124, vcc quad_perm:[1,0,3,2] row_mask:0xf bank_mask:0xf
    v_cndmask_b32_dpp v157, v121, v125, vcc quad_perm:[1,0,3,2] row_mask:0xf bank_mask:0xf
    v_cndmask_b32_dpp v158, v122, v126, vcc quad_perm:[1,0,3,2] row_mask:0xf bank_mask:0xf
    v_mfma_f32_16x16x32_bf16 v[200:203], v[12:15], v[108:111], v[200:203]
    v_cndmask_b32_dpp v159, v123, v127, vcc quad_perm:[1,0,3,2] row_mask:0xf bank_mask:0xf
    s_waitcnt lgkmcnt(3)
    v_mfma_f32_32x32x16_bf16 v[168:183], v[108:111], v[208:211], v[168:183]
    ds_read_b128 v[224:227], v18 offset:21504
    v_cndmask_b32_dpp v164, v128, v132, vcc quad_perm:[1,0,3,2] row_mask:0xf bank_mask:0xf
    v_cndmask_b32_dpp v165, v129, v133, vcc quad_perm:[1,0,3,2] row_mask:0xf bank_mask:0xf
    v_cndmask_b32_dpp v166, v130, v134, vcc quad_perm:[1,0,3,2] row_mask:0xf bank_mask:0xf
    v_cndmask_b32_dpp v167, v131, v135, vcc quad_perm:[1,0,3,2] row_mask:0xf bank_mask:0xf
    v_mfma_f32_32x32x16_bf16 v[184:199], v[112:115], v[112:115], v[184:199]
    s_mov_b64 vcc, s[50:51]
    v_cndmask_b32_dpp v120, v160, v152, vcc quad_perm:[2,3,0,1] row_mask:0xf bank_mask:0xf
    v_cndmask_b32_dpp v121, v161, v153, vcc quad_perm:[2,3,0,1] row_mask:0xf bank_mask:0xf
    v_cndmask_b32_dpp v122, v162, v154, vcc quad_perm:[2,3,0,1] row_mask:0xf bank_mask:0xf
    v_mfma_f32_16x16x32_bf16 v[200:203], v[12:15], v[112:115], v[200:203]
    v_cndmask_b32_dpp v123, v163, v155, vcc quad_perm:[2,3,0,1] row_mask:0xf bank_mask:0xf
    s_waitcnt lgkmcnt(3)
    v_mfma_f32_32x32x16_bf16 v[168:183], v[112:115], v[212:215], v[168:183]
    ds_read_b128 v[228:231], v18 offset:22528
    v_cndmask_b32_dpp v124, v164, v156, vcc quad_perm:[2,3,0,1] row_mask:0xf bank_mask:0xf
    v_cndmask_b32_dpp v125, v165, v157, vcc quad_perm:[2,3,0,1] row_mask:0xf bank_mask:0xf
    v_cndmask_b32_dpp v126, v166, v158, vcc quad_perm:[2,3,0,1] row_mask:0xf bank_mask:0xf
    v_cndmask_b32_dpp v127, v167, v159, vcc quad_perm:[2,3,0,1] row_mask:0xf bank_mask:0xf
    v_mfma_f32_32x32x16_bf16 v[184:199], v[116:119], v[116:119], v[184:199]
    s_not_b64 vcc, vcc
    v_cndmask_b32_dpp v128, v152, v160, vcc quad_perm:[2,3,0,1] row_mask:0xf bank_mask:0xf
    v_cndmask_b32_dpp v129, v153, v161, vcc quad_perm:[2,3,0,1] row_mask:0xf bank_mask:0xf
    v_cndmask_b32_dpp v130, v154, v162, vcc quad_perm:[2,3,0,1] row_mask:0xf bank_mask:0xf
    v_mfma_f32_16x16x32_bf16 v[200:203], v[12:15], v[116:119], v[200:203]
    v_cndmask_b32_dpp v131, v155, v163, vcc quad_perm:[2,3,0,1] row_mask:0xf bank_mask:0xf
    s_waitcnt lgkmcnt(3)
    v_mfma_f32_32x32x16_bf16 v[168:183], v[116:119], v[216:219], v[168:183]
    ds_read_b128 v[232:235], v18 offset:23552
    v_cndmask_b32_dpp v132, v156, v164, vcc quad_perm:[2,3,0,1] row_mask:0xf bank_mask:0xf
    v_cndmask_b32_dpp v133, v157, v165, vcc quad_perm:[2,3,0,1] row_mask:0xf bank_mask:0xf
    v_cndmask_b32_dpp v134, v158, v166, vcc quad_perm:[2,3,0,1] row_mask:0xf bank_mask:0xf
    v_cndmask_b32_dpp v135, v159, v167, vcc quad_perm:[2,3,0,1] row_mask:0xf bank_mask:0xf
    v_mfma_f32_32x32x16_bf16 v[184:199], v[120:123], v[120:123], v[184:199]
    s_waitcnt vmcnt(2)
    s_mov_b64 vcc, s[48:49]
    v_cndmask_b32_dpp v152, v140, v136, vcc quad_perm:[1,0,3,2] row_mask:0xf bank_mask:0xf
    v_cndmask_b32_dpp v153, v141, v137, vcc quad_perm:[1,0,3,2] row_mask:0xf bank_mask:0xf
    v_cndmask_b32_dpp v154, v142, v138, vcc quad_perm:[1,0,3,2] row_mask:0xf bank_mask:0xf
    v_mfma_f32_16x16x32_bf16 v[200:203], v[12:15], v[120:123], v[200:203]
    v_cndmask_b32_dpp v155, v143, v139, vcc quad_perm:[1,0,3,2] row_mask:0xf bank_mask:0xf
    s_waitcnt lgkmcnt(3)
    v_mfma_f32_32x32x16_bf16 v[168:183], v[120:123], v[220:223], v[168:183]
    ds_read_b128 v[204:207], v18 offset:24576
    s_waitcnt vmcnt(0)
    v_cndmask_b32_dpp v160, v148, v144, vcc quad_perm:[1,0,3,2] row_mask:0xf bank_mask:0xf
    v_cndmask_b32_dpp v161, v149, v145, vcc quad_perm:[1,0,3,2] row_mask:0xf bank_mask:0xf
    v_cndmask_b32_dpp v162, v150, v146, vcc quad_perm:[1,0,3,2] row_mask:0xf bank_mask:0xf
    v_cndmask_b32_dpp v163, v151, v147, vcc quad_perm:[1,0,3,2] row_mask:0xf bank_mask:0xf
    v_mfma_f32_32x32x16_bf16 v[184:199], v[124:127], v[124:127], v[184:199]
    s_not_b64 vcc, vcc
    v_cndmask_b32_dpp v156, v136, v140, vcc quad_perm:[1,0,3,2] row_mask:0xf bank_mask:0xf
    v_cndmask_b32_dpp v157, v137, v141, vcc quad_perm:[1,0,3,2] row_mask:0xf bank_mask:0xf
    v_cndmask_b32_dpp v158, v138, v142, vcc quad_perm:[1,0,3,2] row_mask:0xf bank_mask:0xf
    v_mfma_f32_16x16x32_bf16 v[200:203], v[12:15], v[124:127], v[200:203]
    v_cndmask_b32_dpp v159, v139, v143, vcc quad_perm:[1,0,3,2] row_mask:0xf bank_mask:0xf
    s_waitcnt lgkmcnt(3)
    v_mfma_f32_32x32x16_bf16 v[168:183], v[124:127], v[224:227], v[168:183]
    ds_read_b128 v[208:211], v18 offset:25600
    v_cndmask_b32_dpp v164, v144, v148, vcc quad_perm:[1,0,3,2] row_mask:0xf bank_mask:0xf
    v_cndmask_b32_dpp v165, v145, v149, vcc quad_perm:[1,0,3,2] row_mask:0xf bank_mask:0xf
    v_cndmask_b32_dpp v166, v146, v150, vcc quad_perm:[1,0,3,2] row_mask:0xf bank_mask:0xf
    v_cndmask_b32_dpp v167, v147, v151, vcc quad_perm:[1,0,3,2] row_mask:0xf bank_mask:0xf
    v_mfma_f32_32x32x16_bf16 v[184:199], v[128:131], v[128:131], v[184:199]
    s_mov_b64 vcc, s[50:51]
    v_cndmask_b32_dpp v136, v160, v152, vcc quad_perm:[2,3,0,1] row_mask:0xf bank_mask:0xf
    v_cndmask_b32_dpp v137, v161, v153, vcc quad_perm:[2,3,0,1] row_mask:0xf bank_mask:0xf
    v_cndmask_b32_dpp v138, v162, v154, vcc quad_perm:[2,3,0,1] row_mask:0xf bank_mask:0xf
    v_mfma_f32_16x16x32_bf16 v[200:203], v[12:15], v[128:131], v[200:203]
    v_cndmask_b32_dpp v139, v163, v155, vcc quad_perm:[2,3,0,1] row_mask:0xf bank_mask:0xf
    s_waitcnt lgkmcnt(3)
    v_mfma_f32_32x32x16_bf16 v[168:183], v[128:131], v[228:231], v[168:183]
    ds_read_b128 v[212:215], v18 offset:26624
    v_cndmask_b32_dpp v140, v164, v156, vcc quad_perm:[2,3,0,1] row_mask:0xf bank_mask:0xf
    v_cndmask_b32_dpp v141, v165, v157, vcc quad_perm:[2,3,0,1] row_mask:0xf bank_mask:0xf
    v_cndmask_b32_dpp v142, v166, v158, vcc quad_perm:[2,3,0,1] row_mask:0xf bank_mask:0xf
    v_cndmask_b32_dpp v143, v167, v159, vcc quad_perm:[2,3,0,1] row_mask:0xf bank_mask:0xf
    v_mfma_f32_32x32x16_bf16 v[184:199], v[132:135], v[132:135], v[184:199]
    s_not_b64 vcc, vcc
    v_cndmask_b32_dpp v144, v152, v160, vcc quad_perm:[2,3,0,1] row_mask:0xf bank_mask:0xf
    v_cndmask_b32_dpp v145, v153, v161, vcc quad_perm:[2,3,0,1] row_mask:0xf bank_mask:0xf
    v_cndmask_b32_dpp v146, v154, v162, vcc quad_perm:[2,3,0,1] row_mask:0xf bank_mask:0xf
    v_mfma_f32_16x16x32_bf16 v[200:203], v[12:15], v[132:135], v[200:203]
    v_cndmask_b32_dpp v147, v155, v163, vcc quad_perm:[2,3,0,1] row_mask:0xf bank_mask:0xf
    s_waitcnt lgkmcnt(3)
    v_mfma_f32_32x32x16_bf16 v[168:183], v[132:135], v[232:235], v[168:183]
    ds_read_b128 v[216:219], v18 offset:27648
    v_cndmask_b32_dpp v148, v156, v164, vcc quad_perm:[2,3,0,1] row_mask:0xf bank_mask:0xf
    v_cndmask_b32_dpp v149, v157, v165, vcc quad_perm:[2,3,0,1] row_mask:0xf bank_mask:0xf
    v_cndmask_b32_dpp v150, v158, v166, vcc quad_perm:[2,3,0,1] row_mask:0xf bank_mask:0xf
    v_cndmask_b32_dpp v151, v159, v167, vcc quad_perm:[2,3,0,1] row_mask:0xf bank_mask:0xf
    v_mfma_f32_32x32x16_bf16 v[184:199], v[136:139], v[136:139], v[184:199]
    v_mfma_f32_16x16x32_bf16 v[200:203], v[12:15], v[136:139], v[200:203]
    s_waitcnt lgkmcnt(3)
    v_mfma_f32_32x32x16_bf16 v[168:183], v[136:139], v[204:207], v[168:183]
    v_mfma_f32_32x32x16_bf16 v[184:199], v[140:143], v[140:143], v[184:199]
    v_mfma_f32_16x16x32_bf16 v[200:203], v[12:15], v[140:143], v[200:203]
    s_waitcnt lgkmcnt(2)
    v_mfma_f32_32x32x16_bf16 v[168:183], v[140:143], v[208:211], v[168:183]
    v_mfma_f32_32x32x16_bf16 v[184:199], v[144:147], v[144:147], v[184:199]
    v_mfma_f32_16x16x32_bf16 v[200:203], v[12:15], v[144:147], v[200:203]
    s_waitcnt lgkmcnt(1)
    v_mfma_f32_32x32x16_bf16 v[168:183], v[144:147], v[212:215], v[168:183]
    v_mfma_f32_32x32x16_bf16 v[184:199], v[148:151], v[148:151], v[184:199]
    v_mfma_f32_16x16x32_bf16 v[200:203], v[12:15], v[148:151], v[200:203]
    s_waitcnt lgkmcnt(0)
    v_mfma_f32_32x32x16_bf16 v[168:183], v[148:151], v[216:219], v[168:183]
    s_barrier
    ds_read_b64_tr_b16 v[204:205], v36 offset:0
    ds_read_b64_tr_b16 v[206:207], v36 offset:512
    ds_read_b64_tr_b16 v[208:209], v36 offset:2048
    ds_read_b64_tr_b16 v[210:211], v36 offset:2560
    ds_read_b64_tr_b16 v[212:213], v36 offset:4096
    ds_read_b64_tr_b16 v[214:215], v36 offset:4608
    ds_read_b64_tr_b16 v[216:217], v36 offset:6144
    ds_read_b64_tr_b16 v[218:219], v36 offset:6656
    ds_read_b64_tr_b16 v[220:221], v36 offset:8192
    ds_read_b64_tr_b16 v[222:223], v36 offset:8704
    s_waitcnt lgkmcnt(6)
    v_mfma_f32_32x32x16_bf16 v[152:167], v[204:207], v[40:43], 0
    ds_write_b128 v248, v[184:187] offset:0
    ds_write_b128 v248, v[188:191] offset:1024
    ds_write_b128 v248, v[192:195] offset:2048
    ds_read_b64_tr_b16 v[224:225], v36 offset:10240
    ds_read_b64_tr_b16 v[226:227], v36 offset:10752
    v_mfma_f32_32x32x16_bf16 v[152:167], v[208:211], v[44:47], v[152:167]
    ds_write_b128 v248, v[196:199] offset:3072
    ds_read_b32 v25, v246
    v_mul_f32 v24, s15, v200
    ds_read_b64_tr_b16 v[228:229], v36 offset:12288
    ds_read_b64_tr_b16 v[230:231], v36 offset:12800
    s_waitcnt lgkmcnt(11)
    v_mfma_f32_32x32x16_bf16 v[152:167], v[212:215], v[48:51], v[152:167]
    v_cmp_gt_u32 vcc, 32, v1
    v_lshl_add_u32 v3, v8, 2, s62
    v_cvt_pk_bf16_f32 v240, -v24, -v24
    ds_read_b64_tr_b16 v[232:233], v36 offset:14336
    ds_read_b64_tr_b16 v[234:235], v36 offset:14848
    v_mfma_f32_32x32x16_bf16 v[152:167], v[216:219], v[52:55], v[152:167]
    ds_read_b64_tr_b16 v[204:205], v36 offset:16384
    ds_read_b64_tr_b16 v[206:207], v36 offset:16896
    s_waitcnt lgkmcnt(8)
    v_mfma_f32_32x32x16_bf16 v[152:167], v[220:223], v[56:59], v[152:167]
    ds_read_b64_tr_b16 v[208:209], v36 offset:18432
    ds_read_b64_tr_b16 v[210:211], v36 offset:18944
    v_mfma_f32_32x32x16_bf16 v[152:167], v[224:227], v[60:63], v[152:167]
    s_waitcnt lgkmcnt(8)
    v_mul_f32 v25, s15, v25
    v_fma_f32 v25, -v24, v24, v25
    ds_read_b64_tr_b16 v[212:213], v36 offset:20480
    ds_read_b64_tr_b16 v[214:215], v36 offset:20992
    s_waitcnt lgkmcnt(6)
    v_mfma_f32_32x32x16_bf16 v[152:167], v[228:231], v[64:67], v[152:167]
    v_max_f32 v25, 0, v25
    v_cvt_pk_bf16_f32 v2, v25, v25
    v_lshlrev_b32 v2, 16, v2
    ds_read_b64_tr_b16 v[216:217], v36 offset:22528
    ds_read_b64_tr_b16 v[218:219], v36 offset:23040
    v_mfma_f32_32x32x16_bf16 v[152:167], v[232:235], v[68:71], v[152:167]
    v_add_f32 v2, 0x3727c5ac, v2
    v_cvt_pk_bf16_f32 v2, v2, v2
    v_lshlrev_b32 v2, 16, v2
    ds_read_b64_tr_b16 v[220:221], v36 offset:24576
    ds_read_b64_tr_b16 v[222:223], v36 offset:25088
    s_waitcnt lgkmcnt(6)
    v_mfma_f32_32x32x16_bf16 v[152:167], v[204:207], v[72:75], v[152:167]
    v_sqrt_f32 v2, v2
    v_cndmask_b32 v240, 0, v240, vcc
    v_cvt_pk_bf16_f32 v241, -v24, v2
    ds_read_b64_tr_b16 v[224:225], v36 offset:26624
    ds_read_b64_tr_b16 v[226:227], v36 offset:27136
    v_mfma_f32_32x32x16_bf16 v[152:167], v[208:211], v[76:79], v[152:167]
    v_and_b32 v34, 0xffff0000, v241
    v_rcp_f32 v35, v34
    ds_read_b64_tr_b16 v[228:229], v36 offset:28672
    ds_read_b64_tr_b16 v[230:231], v36 offset:29184
    s_waitcnt lgkmcnt(6)
    v_mfma_f32_32x32x16_bf16 v[152:167], v[212:215], v[80:83], v[152:167]
    v_cndmask_b32 v241, 0, v241, vcc
    ds_write_b32 v3, v34 offset:128
    ds_write_b32 v3, v35
    ds_read_b64_tr_b16 v[232:233], v36 offset:30720
    ds_read_b64_tr_b16 v[234:235], v36 offset:31232
    v_mfma_f32_32x32x16_bf16 v[152:167], v[216:219], v[84:87], v[152:167]
    v_mfma_f32_32x32x16_bf16 v[168:183], v[240:243], v[236:239], v[168:183]
    ds_read_b128 v[24:27], v245 offset:0
    ds_read_b128 v[28:31], v245 offset:32
    ds_read_b64_tr_b16 v[204:205], v36 offset:32768
    ds_read_b64_tr_b16 v[206:207], v36 offset:33280
    s_waitcnt lgkmcnt(10)
    v_mfma_f32_32x32x16_bf16 v[152:167], v[220:223], v[88:91], v[152:167]
    ds_read_b64_tr_b16 v[208:209], v36 offset:34816
    ds_read_b64_tr_b16 v[210:211], v36 offset:35328
    v_mfma_f32_32x32x16_bf16 v[152:167], v[224:227], v[92:95], v[152:167]
    s_waitcnt lgkmcnt(4)
    s_nop 1
    v_mul_f32 v24, v24, v168
    v_mul_f32 v25, v25, v169
    v_mul_f32 v26, v26, v170
    ds_read_b64_tr_b16 v[212:213], v36 offset:36864
    ds_read_b64_tr_b16 v[214:215], v36 offset:37376
    v_mfma_f32_32x32x16_bf16 v[152:167], v[228:231], v[96:99], v[152:167]
    v_mul_f32 v27, v27, v171
    v_mul_f32 v28, v28, v172
    v_mul_f32 v29, v29, v173
    ds_read_b64_tr_b16 v[216:217], v36 offset:38912
    ds_read_b64_tr_b16 v[218:219], v36 offset:39424
    v_mfma_f32_32x32x16_bf16 v[152:167], v[232:235], v[100:103], v[152:167]
    v_mul_f32 v30, v30, v174
    v_mul_f32 v31, v31, v175
    v_cvt_pk_bf16_f32 v16, v24, v25
    ds_read_b64_tr_b16 v[220:221], v36 offset:40960
    ds_read_b64_tr_b16 v[222:223], v36 offset:41472
    s_waitcnt lgkmcnt(6)
    v_mfma_f32_32x32x16_bf16 v[152:167], v[204:207], v[104:107], v[152:167]
    v_cvt_pk_bf16_f32 v17, v26, v27
    v_cvt_pk_bf16_f32 v18, v28, v29
    v_cvt_pk_bf16_f32 v19, v30, v31
    ds_read_b64_tr_b16 v[224:225], v36 offset:43008
    ds_read_b64_tr_b16 v[226:227], v36 offset:43520
    v_mfma_f32_32x32x16_bf16 v[152:167], v[208:211], v[108:111], v[152:167]
    buffer_store_dwordx4 v[16:19], v244, s[44:47], s67 offen offset:0 sc0 sc1
    ds_read_b128 v[24:27], v245 offset:64
    ds_read_b128 v[28:31], v245 offset:96
    ds_read_b64_tr_b16 v[228:229], v36 offset:45056
    ds_read_b64_tr_b16 v[230:231], v36 offset:45568
    s_waitcnt lgkmcnt(8)
    v_mfma_f32_32x32x16_bf16 v[152:167], v[212:215], v[112:115], v[152:167]
    ds_read_b64_tr_b16 v[232:233], v36 offset:47104
    ds_read_b64_tr_b16 v[234:235], v36 offset:47616
    v_mfma_f32_32x32x16_bf16 v[152:167], v[216:219], v[116:119], v[152:167]
    s_waitcnt lgkmcnt(4)
    v_mul_f32 v24, v24, v176
    v_mul_f32 v25, v25, v177
    ds_read_b64_tr_b16 v[204:205], v36 offset:49152
    ds_read_b64_tr_b16 v[206:207], v36 offset:49664
    v_mfma_f32_32x32x16_bf16 v[152:167], v[220:223], v[120:123], v[152:167]
    v_mul_f32 v26, v26, v178
    s_barrier
    v_mul_f32 v27, v27, v179
    ds_read_b64_tr_b16 v[208:209], v36 offset:51200
    ds_read_b64_tr_b16 v[210:211], v36 offset:51712
    v_mfma_f32_32x32x16_bf16 v[152:167], v[224:227], v[124:127], v[152:167]
    v_mul_f32 v28, v28, v180
    v_mul_f32 v29, v29, v181
    v_mul_f32 v30, v30, v182
    ds_read_b64_tr_b16 v[212:213], v36 offset:53248
    ds_read_b64_tr_b16 v[214:215], v36 offset:53760
    s_waitcnt lgkmcnt(6)
    v_mfma_f32_32x32x16_bf16 v[152:167], v[228:231], v[128:131], v[152:167]
    v_mul_f32 v31, v31, v183
    v_cvt_pk_bf16_f32 v20, v24, v25
    v_cvt_pk_bf16_f32 v21, v26, v27
    ds_read_b64_tr_b16 v[216:217], v36 offset:55296
    ds_read_b64_tr_b16 v[218:219], v36 offset:55808
    v_mfma_f32_32x32x16_bf16 v[152:167], v[232:235], v[132:135], v[152:167]
    v_cvt_pk_bf16_f32 v22, v28, v29
    v_cvt_pk_bf16_f32 v23, v30, v31
    buffer_store_dwordx4 v[20:23], v244, s[44:47], s67 offen offset:1024 sc0 sc1
    ds_read_b64_tr_b16 v[220:221], v37 offset:0
    ds_read_b64_tr_b16 v[222:223], v37 offset:512
    s_waitcnt lgkmcnt(6)
    v_mfma_f32_32x32x16_bf16 v[152:167], v[204:207], v[136:139], v[152:167]
    v_mul_f32 v33, 0xc0135761, v35
    v_mul_f32 v32, v35, v35
    v_mul_f32 v32, v32, v33
    ds_read_b64_tr_b16 v[224:225], v37 offset:2048
    ds_read_b64_tr_b16 v[226:227], v37 offset:2560
    v_mfma_f32_32x32x16_bf16 v[152:167], v[208:211], v[140:143], v[152:167]
    v_mul_f32 v32, 0x3d372713, v32
    s_barrier
    ds_read_b64 v[236:237], v247 offset:0
    ds_read_b64_tr_b16 v[228:229], v37 offset:4096
    ds_read_b64_tr_b16 v[230:231], v37 offset:4608
    s_waitcnt lgkmcnt(7)
    v_mfma_f32_32x32x16_bf16 v[152:167], v[212:215], v[144:147], v[152:167]
    ds_read_b64_tr_b16 v[232:233], v37 offset:6144
    ds_read_b64_tr_b16 v[234:235], v37 offset:6656
    v_mfma_f32_32x32x16_bf16 v[152:167], v[216:219], v[148:151], v[152:167]
    s_waitcnt lgkmcnt(4)
    v_mfma_f32_32x32x16_bf16 v[152:167], v[236:239], v[240:243], v[152:167]
    ds_read_b64_tr_b16 v[204:205], v37 offset:8192
    ds_read_b64_tr_b16 v[206:207], v37 offset:8704
    v_mfma_f32_32x32x16_bf16 v[168:183], v[220:223], v[40:43], 0
    ds_read_b64_tr_b16 v[208:209], v37 offset:10240
    ds_read_b64_tr_b16 v[210:211], v37 offset:10752
    v_mfma_f32_32x32x16_bf16 v[168:183], v[224:227], v[44:47], v[168:183]
    s_nop 5
    ds_write_b128 v248, v[152:155] offset:0
    ds_read_b64_tr_b16 v[212:213], v37 offset:12288
    ds_read_b64_tr_b16 v[214:215], v37 offset:12800
    s_waitcnt lgkmcnt(7)
    v_mfma_f32_32x32x16_bf16 v[168:183], v[228:231], v[48:51], v[168:183]
    ds_write_b128 v248, v[156:159] offset:1024
    ds_read_b64_tr_b16 v[216:217], v37 offset:14336
    ds_read_b64_tr_b16 v[218:219], v37 offset:14848
    v_mfma_f32_32x32x16_bf16 v[168:183], v[232:235], v[52:55], v[168:183]
    ds_write_b128 v248, v[160:163] offset:2048
    ds_read_b64_tr_b16 v[220:221], v37 offset:16384
    ds_read_b64_tr_b16 v[222:223], v37 offset:16896
    s_waitcnt lgkmcnt(9)
    v_mfma_f32_32x32x16_bf16 v[168:183], v[204:207], v[56:59], v[168:183]
    ds_write_b128 v248, v[164:167] offset:3072
    ds_read_b64_tr_b16 v[224:225], v37 offset:18432
    ds_read_b64_tr_b16 v[226:227], v37 offset:18944
    v_mfma_f32_32x32x16_bf16 v[168:183], v[208:211], v[60:63], v[168:183]
    ds_read_b64_tr_b16 v[228:229], v37 offset:20480
    ds_read_b64_tr_b16 v[230:231], v37 offset:20992
    s_waitcnt lgkmcnt(8)
    v_mfma_f32_32x32x16_bf16 v[168:183], v[212:215], v[64:67], v[168:183]
    s_waitcnt lgkmcnt(4)
    s_barrier
    ds_read_b64_tr_b16 v[232:233], v37 offset:22528
    ds_read_b64_tr_b16 v[234:235], v37 offset:23040
    v_mfma_f32_32x32x16_bf16 v[168:183], v[216:219], v[68:71], v[168:183]
    ds_read_b64 v[236:237], v247 offset:512
    ds_read_b64_tr_b16 v[204:205], v37 offset:24576
    ds_read_b64_tr_b16 v[206:207], v37 offset:25088
    s_waitcnt lgkmcnt(7)
    v_mfma_f32_32x32x16_bf16 v[168:183], v[220:223], v[72:75], v[168:183]
    ds_read_b64_tr_b16 v[208:209], v37 offset:26624
    ds_read_b64_tr_b16 v[210:211], v37 offset:27136
    v_mfma_f32_32x32x16_bf16 v[168:183], v[224:227], v[76:79], v[168:183]
    ds_read_b64_tr_b16 v[212:213], v37 offset:28672
    ds_read_b64_tr_b16 v[214:215], v37 offset:29184
    s_waitcnt lgkmcnt(7)
    v_mfma_f32_32x32x16_bf16 v[168:183], v[228:231], v[80:83], v[168:183]
    ds_read_b64_tr_b16 v[216:217], v37 offset:30720
    ds_read_b64_tr_b16 v[218:219], v37 offset:31232
    v_mfma_f32_32x32x16_bf16 v[168:183], v[232:235], v[84:87], v[168:183]
    ds_read_b64_tr_b16 v[220:221], v37 offset:32768
    ds_read_b64_tr_b16 v[222:223], v37 offset:33280
    s_waitcnt lgkmcnt(6)
    v_mfma_f32_32x32x16_bf16 v[168:183], v[204:207], v[88:91], v[168:183]
    ds_read_b64_tr_b16 v[224:225], v37 offset:34816
    ds_read_b64_tr_b16 v[226:227], v37 offset:35328
    v_mfma_f32_32x32x16_bf16 v[168:183], v[208:211], v[92:95], v[168:183]
    ds_read_b64_tr_b16 v[228:229], v37 offset:36864
    ds_read_b64_tr_b16 v[230:231], v37 offset:37376
    s_waitcnt lgkmcnt(6)
    v_mfma_f32_32x32x16_bf16 v[168:183], v[212:215], v[96:99], v[168:183]
    ds_read_b64_tr_b16 v[232:233], v37 offset:38912
    ds_read_b64_tr_b16 v[234:235], v37 offset:39424
    v_mfma_f32_32x32x16_bf16 v[168:183], v[216:219], v[100:103], v[168:183]
    ds_read_b64_tr_b16 v[204:205], v37 offset:40960
    ds_read_b64_tr_b16 v[206:207], v37 offset:41472
    s_waitcnt lgkmcnt(6)
    v_mfma_f32_32x32x16_bf16 v[168:183], v[220:223], v[104:107], v[168:183]
    ds_read_b64_tr_b16 v[208:209], v37 offset:43008
    ds_read_b64_tr_b16 v[210:211], v37 offset:43520
    v_mfma_f32_32x32x16_bf16 v[168:183], v[224:227], v[108:111], v[168:183]
    ds_read_b64_tr_b16 v[212:213], v37 offset:45056
    ds_read_b64_tr_b16 v[214:215], v37 offset:45568
    s_waitcnt lgkmcnt(6)
    v_mfma_f32_32x32x16_bf16 v[168:183], v[228:231], v[112:115], v[168:183]
    ds_read_b64_tr_b16 v[216:217], v37 offset:47104
    ds_read_b64_tr_b16 v[218:219], v37 offset:47616
    v_mfma_f32_32x32x16_bf16 v[168:183], v[232:235], v[116:119], v[168:183]
    ds_read_b64_tr_b16 v[220:221], v37 offset:49152
    ds_read_b64_tr_b16 v[222:223], v37 offset:49664
    s_waitcnt lgkmcnt(6)
    v_mfma_f32_32x32x16_bf16 v[168:183], v[204:207], v[120:123], v[168:183]
    ds_read_b64_tr_b16 v[224:225], v37 offset:51200
    ds_read_b64_tr_b16 v[226:227], v37 offset:51712
    v_mfma_f32_32x32x16_bf16 v[168:183], v[208:211], v[124:127], v[168:183]
    ds_read_b64_tr_b16 v[228:229], v37 offset:53248
    ds_read_b64_tr_b16 v[230:231], v37 offset:53760
    s_waitcnt lgkmcnt(6)
    v_mfma_f32_32x32x16_bf16 v[168:183], v[212:215], v[128:131], v[168:183]
    ds_read_b64_tr_b16 v[232:233], v37 offset:55296
    ds_read_b64_tr_b16 v[234:235], v37 offset:55808
    v_mfma_f32_32x32x16_bf16 v[168:183], v[216:219], v[132:135], v[168:183]
    ds_read_b64_tr_b16 v[204:205], v38 offset:0
    ds_read_b64_tr_b16 v[206:207], v38 offset:512
    s_waitcnt lgkmcnt(6)
    v_mfma_f32_32x32x16_bf16 v[168:183], v[220:223], v[136:139], v[168:183]
    ds_read_b64_tr_b16 v[208:209], v38 offset:2048
    ds_read_b64_tr_b16 v[210:211], v38 offset:2560
    v_mfma_f32_32x32x16_bf16 v[168:183], v[224:227], v[140:143], v[168:183]
    ds_read_b64_tr_b16 v[212:213], v38 offset:4096
    ds_read_b64_tr_b16 v[214:215], v38 offset:4608
    s_waitcnt lgkmcnt(6)
    v_mfma_f32_32x32x16_bf16 v[168:183], v[228:231], v[144:147], v[168:183]
    ds_read_b64_tr_b16 v[216:217], v38 offset:6144
    ds_read_b64_tr_b16 v[218:219], v38 offset:6656
    v_mfma_f32_32x32x16_bf16 v[168:183], v[232:235], v[148:151], v[168:183]
    v_mfma_f32_32x32x16_bf16 v[168:183], v[236:239], v[240:243], v[168:183]
    ds_read_b64_tr_b16 v[220:221], v38 offset:8192
    ds_read_b64_tr_b16 v[222:223], v38 offset:8704
    s_waitcnt lgkmcnt(6)
    v_mfma_f32_32x32x16_bf16 v[152:167], v[204:207], v[40:43], 0
    ds_read_b64_tr_b16 v[224:225], v38 offset:10240
    ds_read_b64_tr_b16 v[226:227], v38 offset:10752
    v_mfma_f32_32x32x16_bf16 v[152:167], v[208:211], v[44:47], v[152:167]
    s_nop 4
    ds_write_b128 v249, v[168:171] offset:0
    ds_read_b64_tr_b16 v[228:229], v38 offset:12288
    ds_read_b64_tr_b16 v[230:231], v38 offset:12800
    s_waitcnt lgkmcnt(7)
    v_mfma_f32_32x32x16_bf16 v[152:167], v[212:215], v[48:51], v[152:167]
    ds_write_b128 v249, v[172:175] offset:1024
    ds_read_b64_tr_b16 v[232:233], v38 offset:14336
    ds_read_b64_tr_b16 v[234:235], v38 offset:14848
    v_mfma_f32_32x32x16_bf16 v[152:167], v[216:219], v[52:55], v[152:167]
    ds_write_b128 v249, v[176:179] offset:2048
    ds_read_b64_tr_b16 v[204:205], v38 offset:16384
    ds_read_b64_tr_b16 v[206:207], v38 offset:16896
    s_waitcnt lgkmcnt(9)
    v_mfma_f32_32x32x16_bf16 v[152:167], v[220:223], v[56:59], v[152:167]
    ds_write_b128 v249, v[180:183] offset:3072
    ds_read_b64_tr_b16 v[208:209], v38 offset:18432
    ds_read_b64_tr_b16 v[210:211], v38 offset:18944
    v_mfma_f32_32x32x16_bf16 v[152:167], v[224:227], v[60:63], v[152:167]
    ds_read_b64_tr_b16 v[212:213], v38 offset:20480
    ds_read_b64_tr_b16 v[214:215], v38 offset:20992
    s_waitcnt lgkmcnt(8)
    v_mfma_f32_32x32x16_bf16 v[152:167], v[228:231], v[64:67], v[152:167]
    s_waitcnt lgkmcnt(4)
    s_barrier
    ds_read_b64_tr_b16 v[216:217], v38 offset:22528
    ds_read_b64_tr_b16 v[218:219], v38 offset:23040
    v_mfma_f32_32x32x16_bf16 v[152:167], v[232:235], v[68:71], v[152:167]
    ds_read_b64 v[236:237], v247 offset:1024
    ds_read_b64_tr_b16 v[220:221], v38 offset:24576
    ds_read_b64_tr_b16 v[222:223], v38 offset:25088
    s_waitcnt lgkmcnt(7)
    v_mfma_f32_32x32x16_bf16 v[152:167], v[204:207], v[72:75], v[152:167]
    ds_read_b64_tr_b16 v[224:225], v38 offset:26624
    ds_read_b64_tr_b16 v[226:227], v38 offset:27136
    v_mfma_f32_32x32x16_bf16 v[152:167], v[208:211], v[76:79], v[152:167]
    ds_read_b64_tr_b16 v[228:229], v38 offset:28672
    ds_read_b64_tr_b16 v[230:231], v38 offset:29184
    s_waitcnt lgkmcnt(7)
    v_mfma_f32_32x32x16_bf16 v[152:167], v[212:215], v[80:83], v[152:167]
    ds_read_b64_tr_b16 v[232:233], v38 offset:30720
    ds_read_b64_tr_b16 v[234:235], v38 offset:31232
    v_mfma_f32_32x32x16_bf16 v[152:167], v[216:219], v[84:87], v[152:167]
    ds_read_b64_tr_b16 v[204:205], v38 offset:32768
    ds_read_b64_tr_b16 v[206:207], v38 offset:33280
    s_waitcnt lgkmcnt(6)
    v_mfma_f32_32x32x16_bf16 v[152:167], v[220:223], v[88:91], v[152:167]
    ds_read_b64_tr_b16 v[208:209], v38 offset:34816
    ds_read_b64_tr_b16 v[210:211], v38 offset:35328
    v_mfma_f32_32x32x16_bf16 v[152:167], v[224:227], v[92:95], v[152:167]
    ds_read_b64_tr_b16 v[212:213], v38 offset:36864
    ds_read_b64_tr_b16 v[214:215], v38 offset:37376
    s_waitcnt lgkmcnt(6)
    v_mfma_f32_32x32x16_bf16 v[152:167], v[228:231], v[96:99], v[152:167]
    ds_read_b64_tr_b16 v[216:217], v38 offset:38912
    ds_read_b64_tr_b16 v[218:219], v38 offset:39424
    v_mfma_f32_32x32x16_bf16 v[152:167], v[232:235], v[100:103], v[152:167]
    ds_read_b64_tr_b16 v[220:221], v38 offset:40960
    ds_read_b64_tr_b16 v[222:223], v38 offset:41472
    s_waitcnt lgkmcnt(6)
    v_mfma_f32_32x32x16_bf16 v[152:167], v[204:207], v[104:107], v[152:167]
    ds_read_b64_tr_b16 v[224:225], v38 offset:43008
    ds_read_b64_tr_b16 v[226:227], v38 offset:43520
    v_mfma_f32_32x32x16_bf16 v[152:167], v[208:211], v[108:111], v[152:167]
    ds_read_b64_tr_b16 v[228:229], v38 offset:45056
    ds_read_b64_tr_b16 v[230:231], v38 offset:45568
    s_waitcnt lgkmcnt(6)
    v_mfma_f32_32x32x16_bf16 v[152:167], v[212:215], v[112:115], v[152:167]
    ds_read_b64_tr_b16 v[232:233], v38 offset:47104
    ds_read_b64_tr_b16 v[234:235], v38 offset:47616
    v_mfma_f32_32x32x16_bf16 v[152:167], v[216:219], v[116:119], v[152:167]
    ds_read_b64_tr_b16 v[204:205], v38 offset:49152
    ds_read_b64_tr_b16 v[206:207], v38 offset:49664
    s_waitcnt lgkmcnt(6)
    v_mfma_f32_32x32x16_bf16 v[152:167], v[220:223], v[120:123], v[152:167]
    ds_read_b64_tr_b16 v[208:209], v38 offset:51200
    ds_read_b64_tr_b16 v[210:211], v38 offset:51712
    v_mfma_f32_32x32x16_bf16 v[152:167], v[224:227], v[124:127], v[152:167]
    ds_read_b64_tr_b16 v[212:213], v38 offset:53248
    ds_read_b64_tr_b16 v[214:215], v38 offset:53760
    s_waitcnt lgkmcnt(6)
    v_mfma_f32_32x32x16_bf16 v[152:167], v[228:231], v[128:131], v[152:167]
    ds_read_b64_tr_b16 v[216:217], v38 offset:55296
    ds_read_b64_tr_b16 v[218:219], v38 offset:55808
    v_mfma_f32_32x32x16_bf16 v[152:167], v[232:235], v[132:135], v[152:167]
    ds_read_b64_tr_b16 v[220:221], v39 offset:0
    ds_read_b64_tr_b16 v[222:223], v39 offset:512
    s_waitcnt lgkmcnt(6)
    v_mfma_f32_32x32x16_bf16 v[152:167], v[204:207], v[136:139], v[152:167]
    ds_read_b64_tr_b16 v[224:225], v39 offset:2048
    ds_read_b64_tr_b16 v[226:227], v39 offset:2560
    v_mfma_f32_32x32x16_bf16 v[152:167], v[208:211], v[140:143], v[152:167]
    ds_read_b64_tr_b16 v[228:229], v39 offset:4096
    ds_read_b64_tr_b16 v[230:231], v39 offset:4608
    s_waitcnt lgkmcnt(6)
    v_mfma_f32_32x32x16_bf16 v[152:167], v[212:215], v[144:147], v[152:167]
    ds_read_b64_tr_b16 v[232:233], v39 offset:6144
    ds_read_b64_tr_b16 v[234:235], v39 offset:6656
    v_mfma_f32_32x32x16_bf16 v[152:167], v[216:219], v[148:151], v[152:167]
    v_mfma_f32_32x32x16_bf16 v[152:167], v[236:239], v[240:243], v[152:167]
    ds_read_b64_tr_b16 v[204:205], v39 offset:8192
    ds_read_b64_tr_b16 v[206:207], v39 offset:8704
    s_waitcnt lgkmcnt(6)
    v_mfma_f32_32x32x16_bf16 v[168:183], v[220:223], v[40:43], 0
    ds_read_b64_tr_b16 v[208:209], v39 offset:10240
    ds_read_b64_tr_b16 v[210:211], v39 offset:10752
    v_mfma_f32_32x32x16_bf16 v[168:183], v[224:227], v[44:47], v[168:183]
    s_nop 4
    ds_write_b128 v248, v[152:155] offset:0
    ds_read_b64_tr_b16 v[212:213], v39 offset:12288
    ds_read_b64_tr_b16 v[214:215], v39 offset:12800
    s_waitcnt lgkmcnt(7)
    v_mfma_f32_32x32x16_bf16 v[168:183], v[228:231], v[48:51], v[168:183]
    ds_write_b128 v248, v[156:159] offset:1024
    ds_read_b64_tr_b16 v[216:217], v39 offset:14336
    ds_read_b64_tr_b16 v[218:219], v39 offset:14848
    v_mfma_f32_32x32x16_bf16 v[168:183], v[232:235], v[52:55], v[168:183]
    ds_write_b128 v248, v[160:163] offset:2048
    ds_read_b64_tr_b16 v[220:221], v39 offset:16384
    ds_read_b64_tr_b16 v[222:223], v39 offset:16896
    s_waitcnt lgkmcnt(9)
    v_mfma_f32_32x32x16_bf16 v[168:183], v[204:207], v[56:59], v[168:183]
    ds_write_b128 v248, v[164:167] offset:3072
    ds_read_b64_tr_b16 v[224:225], v39 offset:18432
    ds_read_b64_tr_b16 v[226:227], v39 offset:18944
    v_mfma_f32_32x32x16_bf16 v[168:183], v[208:211], v[60:63], v[168:183]
    ds_read_b64_tr_b16 v[228:229], v39 offset:20480
    ds_read_b64_tr_b16 v[230:231], v39 offset:20992
    s_waitcnt lgkmcnt(8)
    v_mfma_f32_32x32x16_bf16 v[168:183], v[212:215], v[64:67], v[168:183]
    s_waitcnt lgkmcnt(4)
    s_barrier
    ds_read_b64_tr_b16 v[232:233], v39 offset:22528
    ds_read_b64_tr_b16 v[234:235], v39 offset:23040
    v_mfma_f32_32x32x16_bf16 v[168:183], v[216:219], v[68:71], v[168:183]
    ds_read_b64 v[236:237], v247 offset:1536
    ds_read_b64_tr_b16 v[204:205], v39 offset:24576
    ds_read_b64_tr_b16 v[206:207], v39 offset:25088
    s_waitcnt lgkmcnt(7)
    v_mfma_f32_32x32x16_bf16 v[168:183], v[220:223], v[72:75], v[168:183]
    ds_read_b64_tr_b16 v[208:209], v39 offset:26624
    ds_read_b64_tr_b16 v[210:211], v39 offset:27136
    v_mfma_f32_32x32x16_bf16 v[168:183], v[224:227], v[76:79], v[168:183]
    ds_read_b64_tr_b16 v[212:213], v39 offset:28672
    ds_read_b64_tr_b16 v[214:215], v39 offset:29184
    s_waitcnt lgkmcnt(7)
    v_mfma_f32_32x32x16_bf16 v[168:183], v[228:231], v[80:83], v[168:183]
    ds_read_b64_tr_b16 v[216:217], v39 offset:30720
    ds_read_b64_tr_b16 v[218:219], v39 offset:31232
    v_mfma_f32_32x32x16_bf16 v[168:183], v[232:235], v[84:87], v[168:183]
    ds_read_b64_tr_b16 v[220:221], v39 offset:32768
    ds_read_b64_tr_b16 v[222:223], v39 offset:33280
    s_waitcnt lgkmcnt(6)
    v_mfma_f32_32x32x16_bf16 v[168:183], v[204:207], v[88:91], v[168:183]
    ds_read_b64_tr_b16 v[224:225], v39 offset:34816
    ds_read_b64_tr_b16 v[226:227], v39 offset:35328
    v_mfma_f32_32x32x16_bf16 v[168:183], v[208:211], v[92:95], v[168:183]
    ds_read_b64_tr_b16 v[228:229], v39 offset:36864
    ds_read_b64_tr_b16 v[230:231], v39 offset:37376
    s_waitcnt lgkmcnt(6)
    v_mfma_f32_32x32x16_bf16 v[168:183], v[212:215], v[96:99], v[168:183]
    ds_read_b64_tr_b16 v[232:233], v39 offset:38912
    ds_read_b64_tr_b16 v[234:235], v39 offset:39424
    v_mfma_f32_32x32x16_bf16 v[168:183], v[216:219], v[100:103], v[168:183]
    ds_read_b64_tr_b16 v[204:205], v39 offset:40960
    ds_read_b64_tr_b16 v[206:207], v39 offset:41472
    s_waitcnt lgkmcnt(6)
    v_mfma_f32_32x32x16_bf16 v[168:183], v[220:223], v[104:107], v[168:183]
    ds_read_b64_tr_b16 v[208:209], v39 offset:43008
    ds_read_b64_tr_b16 v[210:211], v39 offset:43520
    v_mfma_f32_32x32x16_bf16 v[168:183], v[224:227], v[108:111], v[168:183]
    ds_read_b64_tr_b16 v[212:213], v39 offset:45056
    ds_read_b64_tr_b16 v[214:215], v39 offset:45568
    s_waitcnt lgkmcnt(6)
    v_mfma_f32_32x32x16_bf16 v[168:183], v[228:231], v[112:115], v[168:183]
    ds_read_b64_tr_b16 v[216:217], v39 offset:47104
    ds_read_b64_tr_b16 v[218:219], v39 offset:47616
    v_mfma_f32_32x32x16_bf16 v[168:183], v[232:235], v[116:119], v[168:183]
    ds_read_b64_tr_b16 v[220:221], v39 offset:49152
    ds_read_b64_tr_b16 v[222:223], v39 offset:49664
    s_waitcnt lgkmcnt(6)
    v_mfma_f32_32x32x16_bf16 v[168:183], v[204:207], v[120:123], v[168:183]
    ds_read_b64_tr_b16 v[224:225], v39 offset:51200
    ds_read_b64_tr_b16 v[226:227], v39 offset:51712
    v_mfma_f32_32x32x16_bf16 v[168:183], v[208:211], v[124:127], v[168:183]
    ds_read_b64_tr_b16 v[228:229], v39 offset:53248
    ds_read_b64_tr_b16 v[230:231], v39 offset:53760
    s_waitcnt lgkmcnt(6)
    v_mfma_f32_32x32x16_bf16 v[168:183], v[212:215], v[128:131], v[168:183]
    ds_read_b64_tr_b16 v[232:233], v39 offset:55296
    ds_read_b64_tr_b16 v[234:235], v39 offset:55808
    v_mfma_f32_32x32x16_bf16 v[168:183], v[216:219], v[132:135], v[168:183]
    s_waitcnt lgkmcnt(4)
    v_mfma_f32_32x32x16_bf16 v[168:183], v[220:223], v[136:139], v[168:183]
    v_mfma_f32_32x32x16_bf16 v[168:183], v[224:227], v[140:143], v[168:183]
    s_waitcnt lgkmcnt(0)
    v_mfma_f32_32x32x16_bf16 v[168:183], v[228:231], v[144:147], v[168:183]
    v_mfma_f32_32x32x16_bf16 v[168:183], v[232:235], v[148:151], v[168:183]
    v_mfma_f32_32x32x16_bf16 v[168:183], v[236:239], v[240:243], v[168:183]
    s_nop 11
    ds_write_b128 v249, v[168:171] offset:0
    ds_write_b128 v249, v[172:175] offset:1024
    v_pk_mul_f32 v[24:25], v[176:177], v[176:177]
    v_pk_mul_f32 v[26:27], v[178:179], v[178:179]
    v_pk_fma_f32 v[24:25], v[24:25], v[32:33], v[32:33] op_sel:[0,0,1] op_sel_hi:[1,0,1]
    v_pk_fma_f32 v[26:27], v[26:27], v[32:33], v[32:33] op_sel:[0,0,1] op_sel_hi:[1,0,1]
    v_pk_mul_f32 v[24:25], v[24:25], v[176:177]
    v_pk_mul_f32 v[26:27], v[26:27], v[178:179]
    s_waitcnt lgkmcnt(0)
    s_barrier
    v_exp_f32 v24, v24
    v_exp_f32 v25, v25
    v_exp_f32 v26, v26
    v_exp_f32 v27, v27
    v_pk_fma_f32 v[24:25], v[24:25], v[34:35], v[34:35] op_sel_hi:[1,0,0]
    v_pk_fma_f32 v[26:27], v[26:27], v[34:35], v[34:35] op_sel_hi:[1,0,0]
    v_rcp_f32 v24, v24
    v_rcp_f32 v25, v25
    v_rcp_f32 v26, v26
    v_rcp_f32 v27, v27
    v_pk_mul_f32 v[24:25], v[24:25], v[176:177]
    v_pk_mul_f32 v[26:27], v[26:27], v[178:179]
    v_cvt_pk_bf16_f32 v20, v24, v25
    v_cvt_pk_bf16_f32 v21, v26, v27
    v_pk_mul_f32 v[28:29], v[180:181], v[180:181]
    v_pk_mul_f32 v[30:31], v[182:183], v[182:183]
    v_pk_fma_f32 v[28:29], v[28:29], v[32:33], v[32:33] op_sel:[0,0,1] op_sel_hi:[1,0,1]
    v_pk_fma_f32 v[30:31], v[30:31], v[32:33], v[32:33] op_sel:[0,0,1] op_sel_hi:[1,0,1]
    v_pk_mul_f32 v[28:29], v[28:29], v[180:181]
    v_pk_mul_f32 v[30:31], v[30:31], v[182:183]
    v_exp_f32 v28, v28
    v_exp_f32 v29, v29
    v_exp_f32 v30, v30
    v_exp_f32 v31, v31
    v_pk_fma_f32 v[28:29], v[28:29], v[34:35], v[34:35] op_sel_hi:[1,0,0]
    v_pk_fma_f32 v[30:31], v[30:31], v[34:35], v[34:35] op_sel_hi:[1,0,0]
    v_rcp_f32 v28, v28
    v_rcp_f32 v29, v29
    v_rcp_f32 v30, v30
    v_rcp_f32 v31, v31
    v_pk_mul_f32 v[28:29], v[28:29], v[180:181]
    v_pk_mul_f32 v[30:31], v[30:31], v[182:183]
    v_cvt_pk_bf16_f32 v22, v28, v29
    v_cvt_pk_bf16_f32 v23, v30, v31
    buffer_store_dwordx4 v[20:23], v6, s[44:47], s64 offen offset:3072 sc0 sc1
    s_endpgm
k1_kernel_help:
    v_mul_f32 v5, s15, v2
    v_floor_f32 v5, v5
    v_fma_f32 v5, v5, s65, v2
    v_fma_f32 v24, v5, s15, v4
    v_add_f32 v25, v24, v57
    v_add_f32 v26, v24, v58
    v_add_f32 v27, v24, v59
    v_add_f32 v28, v24, v60
    v_add_f32 v29, v24, v61
    v_add_f32 v30, v24, v62
    v_add_f32 v31, v24, v63
    v_cos_f32 v24, v24
    v_cos_f32 v25, v25
    v_cos_f32 v26, v26
    v_cos_f32 v27, v27
    v_cos_f32 v28, v28
    v_cos_f32 v29, v29
    v_cos_f32 v30, v30
    v_cos_f32 v31, v31
    v_add_f32 v2, v2, v3
    v_cvt_pk_bf16_f32 v52, v24, v25
    v_cvt_pk_bf16_f32 v53, v26, v27
    v_cvt_pk_bf16_f32 v54, v28, v29
    v_cvt_pk_bf16_f32 v55, v30, v31
    ds_write_b128 v56, v[52:55] offset:3072
    v_lshrrev_b32 v2, 3, v1
    v_and_b32 v3, 7, v1
    v_lshlrev_b32 v4, 1, v2
    v_and_b32 v4, 4, v4
    v_xor_b32 v4, v4, v3
    v_mul_u32_u24 v92, 3584, v2
    v_lshl_add_u32 v92, v4, 4, v92
    s_lshl_b32 s14, s6, 7
    v_add_u32 v92, s14, v92
    v_xor_b32 v93, 128, v92
    s_mul_i32 s56, s69, 28672
    s_lshl_b32 s10, s7, 8
    s_add_u32 s56, s56, s10
    s_add_u32 s10, s10, s14
    s_lshl_b32 s11, s69, 6
    s_xor_b32 s10, s10, s11
    s_mul_i32 s57, s12, 28672
    s_lshl_b32 s58, s69, 10
    s_add_u32 s57, s57, s58
    s_xor_b32 s58, s57, 28672
    s_mul_i32 s60, s12, 7
    s_lshl_b32 s61, s13, 1
    s_add_u32 s60, s60, s61
    s_cmp_ge_u32 s60, 14
    s_cselect_b32 s61, 14, 0
    s_sub_u32 s60, s60, s61
    s_mul_i32 s60, s60, 114688
    s_add_u32 s60, s60, s56
    s_add_u32 s61, s56, 1605632
    v_bfe_u32 v2, v1, 2, 2
    v_lshl_add_u32 v3, v7, 3, v2
    v_lshlrev_b32 v3, 7, v3
    v_bfe_u32 v4, v1, 3, 1
    v_lshl_add_u32 v3, v4, 6, v3
    v_bfe_u32 v4, v1, 4, 1
    v_lshl_add_u32 v3, v4, 5, v3
    v_and_b32 v4, 3, v1
    v_lshl_add_u32 v36, v4, 3, v3
    v_lshrrev_b32 v2, 2, v1
    v_xor_b32 v2, v2, v1
    v_and_b32 v2, 4, v2
    v_cmp_eq_u32 vcc, 0, v2
    v_mov_b32 v2, 0x3f803f80
    s_nop 0
    v_cndmask_b32 v12, 0, v2, vcc
    v_cndmask_b32 v13, 0, v2, vcc
    v_cndmask_b32 v14, 0, v2, vcc
    v_cndmask_b32 v15, 0, v2, vcc
    v_mul_u32_u24 v2, 27648, v7
    s_lshl_b32 s12, s69, 10
    v_add3_u32 v36, v36, v2, s12
    v_xor_b32 v37, 64, v36
    v_add_u32 v38, 57344, v36
    v_add_u32 v39, 57344, v37
    v_add_u32 v95, s9, v6
    s_lshl_b32 s12, s69, 2
    s_add_u32 s12, s12, 159744
    v_lshl_add_u32 v97, v8, 4, s12
    s_lshl_b32 s12, s69, 9
    s_add_u32 s12, s12, 159744
    v_lshl_add_u32 v98, v8, 4, s12
    v_lshl_add_u32 v96, v8, 3, s12
    v_lshl_add_u32 v5, v8, 2, s62
    s_waitcnt lgkmcnt(0)
    s_mov_b32 s40, s24
    s_and_b32 s41, s25, 0xffff
    s_mov_b32 s42, 1605632
    s_mov_b32 s43, 0x00020000
    s_mov_b32 s44, s34
    s_and_b32 s45, s35, 0xffff
    s_mov_b32 s46, 268435456
    s_mov_b32 s47, 0x00020000
    s_mov_b32 s48, s26
    s_and_b32 s49, s27, 0xffff
    s_mov_b32 s50, 3584
    s_mov_b32 s51, 0x00020000
    s_barrier
    v_lshlrev_b32 v4, 1, v8
    buffer_load_ushort v94, v4, s[48:51], s10 offen
    s_mov_b32 s16, s60
    s_add_u32 m0, s57, 0
    s_nop 0
    buffer_load_dwordx4 v92, s[40:43], s16 offen lds
    s_add_u32 s17, s16, 114688
    s_cmp_eq_u32 s17, s61
    s_cselect_b32 s17, s56, s17
    s_add_u32 m0, s57, 4096
    s_nop 0
    buffer_load_dwordx4 v92, s[40:43], s17 offen lds
    s_add_u32 s18, s17, 114688
    s_cmp_eq_u32 s18, s61
    s_cselect_b32 s18, s56, s18
    s_add_u32 m0, s57, 8192
    s_nop 0
    buffer_load_dwordx4 v92, s[40:43], s18 offen lds
    s_add_u32 s19, s18, 114688
    s_cmp_eq_u32 s19, s61
    s_cselect_b32 s19, s56, s19
    s_add_u32 m0, s57, 12288
    s_nop 0
    buffer_load_dwordx4 v92, s[40:43], s19 offen lds
    s_add_u32 s20, s19, 114688
    s_cmp_eq_u32 s20, s61
    s_cselect_b32 s20, s56, s20
    s_add_u32 m0, s57, 16384
    s_nop 0
    buffer_load_dwordx4 v92, s[40:43], s20 offen lds
    s_add_u32 s21, s20, 114688
    s_cmp_eq_u32 s21, s61
    s_cselect_b32 s21, s56, s21
    s_add_u32 m0, s57, 20480
    s_nop 0
    buffer_load_dwordx4 v92, s[40:43], s21 offen lds
    s_add_u32 s22, s21, 114688
    s_cmp_eq_u32 s22, s61
    s_cselect_b32 s22, s56, s22
    s_add_u32 m0, s57, 24576
    s_nop 0
    buffer_load_dwordx4 v92, s[40:43], s22 offen lds
    s_add_u32 s23, s22, 114688
    s_cmp_eq_u32 s23, s61
    s_cselect_b32 s23, s56, s23
    s_add_u32 m0, s58, 0
    s_nop 0
    buffer_load_dwordx4 v92, s[40:43], s23 offen lds
    s_add_u32 s24, s23, 114688
    s_cmp_eq_u32 s24, s61
    s_cselect_b32 s24, s56, s24
    s_add_u32 m0, s58, 4096
    s_nop 0
    buffer_load_dwordx4 v92, s[40:43], s24 offen lds
    s_add_u32 s25, s24, 114688
    s_cmp_eq_u32 s25, s61
    s_cselect_b32 s25, s56, s25
    s_add_u32 m0, s58, 8192
    s_nop 0
    buffer_load_dwordx4 v92, s[40:43], s25 offen lds
    s_add_u32 s26, s25, 114688
    s_cmp_eq_u32 s26, s61
    s_cselect_b32 s26, s56, s26
    s_add_u32 m0, s58, 12288
    s_nop 0
    buffer_load_dwordx4 v92, s[40:43], s26 offen lds
    s_add_u32 s27, s26, 114688
    s_cmp_eq_u32 s27, s61
    s_cselect_b32 s27, s56, s27
    s_add_u32 m0, s58, 16384
    s_nop 0
    buffer_load_dwordx4 v92, s[40:43], s27 offen lds
    s_add_u32 s28, s27, 114688
    s_cmp_eq_u32 s28, s61
    s_cselect_b32 s28, s56, s28
    s_add_u32 m0, s58, 20480
    s_nop 0
    buffer_load_dwordx4 v92, s[40:43], s28 offen lds
    s_add_u32 s29, s28, 114688
    s_cmp_eq_u32 s29, s61
    s_cselect_b32 s29, s56, s29
    s_add_u32 m0, s58, 24576
    s_nop 0
    buffer_load_dwordx4 v92, s[40:43], s29 offen lds
    s_add_u32 m0, s57, 57344
    s_nop 0
    buffer_load_dwordx4 v93, s[40:43], s16 offen lds
    s_add_u32 m0, s57, 61440
    s_nop 0
    buffer_load_dwordx4 v93, s[40:43], s17 offen lds
    s_add_u32 m0, s57, 65536
    s_nop 0
    buffer_load_dwordx4 v93, s[40:43], s18 offen lds
    s_add_u32 m0, s57, 69632
    s_nop 0
    buffer_load_dwordx4 v93, s[40:43], s19 offen lds
    s_add_u32 m0, s57, 73728
    s_nop 0
    buffer_load_dwordx4 v93, s[40:43], s20 offen lds
    s_add_u32 m0, s57, 77824
    s_nop 0
    buffer_load_dwordx4 v93, s[40:43], s21 offen lds
    s_add_u32 m0, s57, 81920
    s_nop 0
    buffer_load_dwordx4 v93, s[40:43], s22 offen lds
    s_add_u32 m0, s58, 57344
    s_nop 0
    buffer_load_dwordx4 v93, s[40:43], s23 offen lds
    s_add_u32 m0, s58, 61440
    s_nop 0
    buffer_load_dwordx4 v93, s[40:43], s24 offen lds
    s_add_u32 m0, s58, 65536
    s_nop 0
    buffer_load_dwordx4 v93, s[40:43], s25 offen lds
    s_add_u32 m0, s58, 69632
    s_nop 0
    buffer_load_dwordx4 v93, s[40:43], s26 offen lds
    s_add_u32 m0, s58, 73728
    s_nop 0
    buffer_load_dwordx4 v93, s[40:43], s27 offen lds
    s_add_u32 m0, s58, 77824
    s_nop 0
    buffer_load_dwordx4 v93, s[40:43], s28 offen lds
    s_add_u32 m0, s58, 81920
    s_nop 0
    buffer_load_dwordx4 v93, s[40:43], s29 offen lds
    s_waitcnt vmcnt(14)
    s_barrier
    s_setprio 3
    ds_read_b64_tr_b16 v[40:41], v36 offset:0
    ds_read_b64_tr_b16 v[42:43], v36 offset:512
    ds_read_b64_tr_b16 v[44:45], v36 offset:4096
    ds_read_b64_tr_b16 v[46:47], v36 offset:4608
    ds_read_b64_tr_b16 v[48:49], v36 offset:8192
    ds_read_b64_tr_b16 v[50:51], v36 offset:8704
    ds_read_b64_tr_b16 v[52:53], v36 offset:12288
    ds_read_b64_tr_b16 v[54:55], v36 offset:12800
    ds_read_b64_tr_b16 v[56:57], v36 offset:16384
    ds_read_b64_tr_b16 v[58:59], v36 offset:16896
    ds_read_b64_tr_b16 v[60:61], v36 offset:20480
    ds_read_b64_tr_b16 v[62:63], v36 offset:20992
    s_waitcnt lgkmcnt(10)
    v_mfma_f32_16x16x32_bf16 v[76:79], v[12:15], v[40:43], 0
    ds_read_b64_tr_b16 v[64:65], v36 offset:24576
    ds_read_b64_tr_b16 v[66:67], v36 offset:25088
    s_waitcnt lgkmcnt(10)
    v_mfma_f32_16x16x32_bf16 v[76:79], v[12:15], v[44:47], v[76:79]
    ds_read_b64_tr_b16 v[68:69], v37 offset:0
    ds_read_b64_tr_b16 v[70:71], v37 offset:512
    s_waitcnt lgkmcnt(10)
    v_mfma_f32_16x16x32_bf16 v[76:79], v[12:15], v[48:51], v[76:79]
    ds_read_b64_tr_b16 v[40:41], v37 offset:4096
    ds_read_b64_tr_b16 v[42:43], v37 offset:4608
    s_waitcnt lgkmcnt(10)
    v_mfma_f32_16x16x32_bf16 v[76:79], v[12:15], v[52:55], v[76:79]
    ds_read_b64_tr_b16 v[44:45], v37 offset:8192
    ds_read_b64_tr_b16 v[46:47], v37 offset:8704
    s_waitcnt lgkmcnt(10)
    v_mfma_f32_16x16x32_bf16 v[76:79], v[12:15], v[56:59], v[76:79]
    ds_read_b64_tr_b16 v[48:49], v37 offset:12288
    ds_read_b64_tr_b16 v[50:51], v37 offset:12800
    s_waitcnt lgkmcnt(10)
    v_mfma_f32_16x16x32_bf16 v[76:79], v[12:15], v[60:63], v[76:79]
    ds_read_b64_tr_b16 v[52:53], v37 offset:16384
    ds_read_b64_tr_b16 v[54:55], v37 offset:16896
    s_waitcnt lgkmcnt(10)
    v_mfma_f32_16x16x32_bf16 v[76:79], v[12:15], v[64:67], v[76:79]
    ds_read_b64_tr_b16 v[56:57], v37 offset:20480
    ds_read_b64_tr_b16 v[58:59], v37 offset:20992
    s_waitcnt lgkmcnt(10)
    v_mfma_f32_16x16x32_bf16 v[80:83], v[12:15], v[68:71], 0
    ds_read_b64_tr_b16 v[60:61], v37 offset:24576
    ds_read_b64_tr_b16 v[62:63], v37 offset:25088
    s_waitcnt lgkmcnt(10)
    v_mfma_f32_16x16x32_bf16 v[80:83], v[12:15], v[40:43], v[80:83]
    s_waitcnt lgkmcnt(8)
    v_mfma_f32_16x16x32_bf16 v[80:83], v[12:15], v[44:47], v[80:83]
    s_waitcnt lgkmcnt(6)
    v_mfma_f32_16x16x32_bf16 v[80:83], v[12:15], v[48:51], v[80:83]
    s_waitcnt lgkmcnt(4)
    v_mfma_f32_16x16x32_bf16 v[80:83], v[12:15], v[52:55], v[80:83]
    s_waitcnt lgkmcnt(2)
    v_mfma_f32_16x16x32_bf16 v[80:83], v[12:15], v[56:59], v[80:83]
    s_waitcnt lgkmcnt(0)
    v_mfma_f32_16x16x32_bf16 v[80:83], v[12:15], v[60:63], v[80:83]
    s_waitcnt vmcnt(0)
    ds_read_b64_tr_b16 v[64:65], v38 offset:0
    ds_read_b64_tr_b16 v[66:67], v38 offset:512
    ds_read_b64_tr_b16 v[68:69], v38 offset:4096
    ds_read_b64_tr_b16 v[70:71], v38 offset:4608
    ds_read_b64_tr_b16 v[40:41], v38 offset:8192
    ds_read_b64_tr_b16 v[42:43], v38 offset:8704
    ds_read_b64_tr_b16 v[44:45], v38 offset:12288
    ds_read_b64_tr_b16 v[46:47], v38 offset:12800
    ds_read_b64_tr_b16 v[48:49], v38 offset:16384
    ds_read_b64_tr_b16 v[50:51], v38 offset:16896
    ds_read_b64_tr_b16 v[52:53], v38 offset:20480
    ds_read_b64_tr_b16 v[54:55], v38 offset:20992
    s_waitcnt lgkmcnt(10)
    v_mfma_f32_16x16x32_bf16 v[84:87], v[12:15], v[64:67], 0
    ds_read_b64_tr_b16 v[56:57], v38 offset:24576
    ds_read_b64_tr_b16 v[58:59], v38 offset:25088
    s_waitcnt lgkmcnt(10)
    v_mfma_f32_16x16x32_bf16 v[84:87], v[12:15], v[68:71], v[84:87]
    ds_read_b64_tr_b16 v[60:61], v39 offset:0
    ds_read_b64_tr_b16 v[62:63], v39 offset:512
    s_waitcnt lgkmcnt(10)
    v_mfma_f32_16x16x32_bf16 v[84:87], v[12:15], v[40:43], v[84:87]
    ds_read_b64_tr_b16 v[64:65], v39 offset:4096
    ds_read_b64_tr_b16 v[66:67], v39 offset:4608
    s_waitcnt lgkmcnt(10)
    v_mfma_f32_16x16x32_bf16 v[84:87], v[12:15], v[44:47], v[84:87]
    ds_read_b64_tr_b16 v[68:69], v39 offset:8192
    ds_read_b64_tr_b16 v[70:71], v39 offset:8704
    s_waitcnt lgkmcnt(10)
    v_mfma_f32_16x16x32_bf16 v[84:87], v[12:15], v[48:51], v[84:87]
    ds_read_b64_tr_b16 v[40:41], v39 offset:12288
    ds_read_b64_tr_b16 v[42:43], v39 offset:12800
    s_waitcnt lgkmcnt(10)
    v_mfma_f32_16x16x32_bf16 v[84:87], v[12:15], v[52:55], v[84:87]
    ds_read_b64_tr_b16 v[44:45], v39 offset:16384
    ds_read_b64_tr_b16 v[46:47], v39 offset:16896
    s_waitcnt lgkmcnt(10)
    v_mfma_f32_16x16x32_bf16 v[84:87], v[12:15], v[56:59], v[84:87]
    ds_read_b64_tr_b16 v[48:49], v39 offset:20480
    ds_read_b64_tr_b16 v[50:51], v39 offset:20992
    s_waitcnt lgkmcnt(10)
    v_mfma_f32_16x16x32_bf16 v[88:91], v[12:15], v[60:63], 0
    ds_read_b64_tr_b16 v[52:53], v39 offset:24576
    ds_read_b64_tr_b16 v[54:55], v39 offset:25088
    s_waitcnt lgkmcnt(10)
    v_mfma_f32_16x16x32_bf16 v[88:91], v[12:15], v[64:67], v[88:91]
    s_waitcnt lgkmcnt(8)
    v_mfma_f32_16x16x32_bf16 v[88:91], v[12:15], v[68:71], v[88:91]
    s_waitcnt lgkmcnt(6)
    v_mfma_f32_16x16x32_bf16 v[88:91], v[12:15], v[40:43], v[88:91]
    s_waitcnt lgkmcnt(4)
    v_mfma_f32_16x16x32_bf16 v[88:91], v[12:15], v[44:47], v[88:91]
    s_waitcnt lgkmcnt(2)
    v_mfma_f32_16x16x32_bf16 v[88:91], v[12:15], v[48:51], v[88:91]
    s_waitcnt lgkmcnt(0)
    v_mfma_f32_16x16x32_bf16 v[88:91], v[12:15], v[52:55], v[88:91]
    ds_write_b32 v97, v76 offset:0
    ds_write_b32 v97, v80 offset:512
    ds_write_b32 v97, v84 offset:1024
    s_nop 4
    ds_write_b32 v97, v88 offset:1536
    s_waitcnt lgkmcnt(0)
    s_barrier
    ds_read_b128 v[72:75], v98
    s_waitcnt lgkmcnt(0)
    v_add_f32 v72, v72, v73
    v_add_f32 v74, v74, v75
    v_add_f32 v72, v72, v74
    v_cvt_pk_bf16_f32 v73, v72, v72
    v_lshlrev_b32 v74, 16, v73
    v_sub_f32 v75, v72, v74
    v_cvt_pk_bf16_f32 v24, v72, v75
    v_and_b32 v74, 0xffff0000, v24
    v_sub_f32 v75, v75, v74
    v_cvt_pk_bf16_f32 v25, v75, 0
    v_lshl_or_b32 v25, v94, 16, v25
    ds_write_b64 v96, v[24:25]
    s_waitcnt lgkmcnt(0)
    s_barrier
    s_setprio 0
    ds_read_b32 v34, v5 offset:128
    ds_read_b32 v35, v5
    v_add_u32 v2, -28672, v95
    s_waitcnt lgkmcnt(0)
    v_mul_f32 v33, 0xc0135761, v35
    v_mul_f32 v32, v35, v35
    v_mul_f32 v32, v32, v33
    v_mul_f32 v32, 0x3d372713, v32
    s_barrier
    ds_read_b128 v[76:79], v95 offset:0
    ds_read_b128 v[80:83], v95 offset:1024
    ds_read_b128 v[84:87], v95 offset:2048
    ds_read_b128 v[88:91], v95 offset:3072
    s_waitcnt lgkmcnt(2)
    v_mul_f32 v24, v76, v76
    v_mul_f32 v25, v77, v77
    v_mul_f32 v26, v78, v78
    v_mul_f32 v27, v79, v79
    v_mul_f32 v28, v80, v80
    v_mul_f32 v29, v81, v81
    v_mul_f32 v30, v82, v82
    v_mul_f32 v31, v83, v83
    v_fma_f32 v24, v24, v32, v33
    v_fma_f32 v25, v25, v32, v33
    v_fma_f32 v26, v26, v32, v33
    v_fma_f32 v27, v27, v32, v33
    v_fma_f32 v28, v28, v32, v33
    v_fma_f32 v29, v29, v32, v33
    v_fma_f32 v30, v30, v32, v33
    v_fma_f32 v31, v31, v32, v33
    v_mul_f32 v24, v24, v76
    v_mul_f32 v25, v25, v77
    v_mul_f32 v26, v26, v78
    v_mul_f32 v27, v27, v79
    v_mul_f32 v28, v28, v80
    v_mul_f32 v29, v29, v81
    v_mul_f32 v30, v30, v82
    v_mul_f32 v31, v31, v83
    v_exp_f32 v24, v24
    v_exp_f32 v25, v25
    v_exp_f32 v26, v26
    v_exp_f32 v27, v27
    v_exp_f32 v28, v28
    v_exp_f32 v29, v29
    v_exp_f32 v30, v30
    v_exp_f32 v31, v31
    v_fma_f32 v24, v24, v34, v34
    v_fma_f32 v25, v25, v34, v34
    v_rcp_f32 v24, v24
    v_fma_f32 v26, v26, v34, v34
    v_rcp_f32 v25, v25
    v_fma_f32 v27, v27, v34, v34
    v_rcp_f32 v26, v26
    v_fma_f32 v28, v28, v34, v34
    v_rcp_f32 v27, v27
    v_fma_f32 v29, v29, v34, v34
    v_rcp_f32 v28, v28
    v_fma_f32 v30, v30, v34, v34
    v_rcp_f32 v29, v29
    v_fma_f32 v31, v31, v34, v34
    v_rcp_f32 v30, v30
    v_mul_f32 v24, v24, v76
    v_rcp_f32 v31, v31
    v_mul_f32 v25, v25, v77
    v_mul_f32 v26, v26, v78
    v_mul_f32 v27, v27, v79
    v_mul_f32 v28, v28, v80
    v_mul_f32 v29, v29, v81
    v_mul_f32 v30, v30, v82
    v_mul_f32 v31, v31, v83
    v_cvt_pk_bf16_f32 v16, v24, v25
    v_cvt_pk_bf16_f32 v17, v26, v27
    v_cvt_pk_bf16_f32 v18, v28, v29
    v_cvt_pk_bf16_f32 v19, v30, v31
    buffer_store_dwordx4 v[16:19], v6, s[44:47], s63 offen offset:0 sc0 sc1
    s_waitcnt lgkmcnt(0)
    v_mul_f32 v24, v84, v84
    v_mul_f32 v25, v85, v85
    v_mul_f32 v26, v86, v86
    v_mul_f32 v27, v87, v87
    v_mul_f32 v28, v88, v88
    v_mul_f32 v29, v89, v89
    v_mul_f32 v30, v90, v90
    v_mul_f32 v31, v91, v91
    v_fma_f32 v24, v24, v32, v33
    v_fma_f32 v25, v25, v32, v33
    v_fma_f32 v26, v26, v32, v33
    v_fma_f32 v27, v27, v32, v33
    v_fma_f32 v28, v28, v32, v33
    v_fma_f32 v29, v29, v32, v33
    v_fma_f32 v30, v30, v32, v33
    v_fma_f32 v31, v31, v32, v33
    v_mul_f32 v24, v24, v84
    v_mul_f32 v25, v25, v85
    v_mul_f32 v26, v26, v86
    v_mul_f32 v27, v27, v87
    v_mul_f32 v28, v28, v88
    v_mul_f32 v29, v29, v89
    v_mul_f32 v30, v30, v90
    v_mul_f32 v31, v31, v91
    v_exp_f32 v24, v24
    v_exp_f32 v25, v25
    v_exp_f32 v26, v26
    v_exp_f32 v27, v27
    v_exp_f32 v28, v28
    v_exp_f32 v29, v29
    v_exp_f32 v30, v30
    v_exp_f32 v31, v31
    v_fma_f32 v24, v24, v34, v34
    v_fma_f32 v25, v25, v34, v34
    v_rcp_f32 v24, v24
    v_fma_f32 v26, v26, v34, v34
    v_rcp_f32 v25, v25
    v_fma_f32 v27, v27, v34, v34
    v_rcp_f32 v26, v26
    v_fma_f32 v28, v28, v34, v34
    v_rcp_f32 v27, v27
    v_fma_f32 v29, v29, v34, v34
    v_rcp_f32 v28, v28
    v_fma_f32 v30, v30, v34, v34
    v_rcp_f32 v29, v29
    v_fma_f32 v31, v31, v34, v34
    v_rcp_f32 v30, v30
    v_mul_f32 v24, v24, v84
    v_rcp_f32 v31, v31
    v_mul_f32 v25, v25, v85
    v_mul_f32 v26, v26, v86
    v_mul_f32 v27, v27, v87
    v_mul_f32 v28, v28, v88
    v_mul_f32 v29, v29, v89
    v_mul_f32 v30, v30, v90
    v_mul_f32 v31, v31, v91
    v_cvt_pk_bf16_f32 v20, v24, v25
    v_cvt_pk_bf16_f32 v21, v26, v27
    v_cvt_pk_bf16_f32 v22, v28, v29
    v_cvt_pk_bf16_f32 v23, v30, v31
    buffer_store_dwordx4 v[20:23], v6, s[44:47], s63 offen offset:1024 sc0 sc1
    s_barrier
    ds_read_b128 v[76:79], v2 offset:0
    ds_read_b128 v[80:83], v2 offset:1024
    ds_read_b128 v[84:87], v2 offset:2048
    ds_read_b128 v[88:91], v2 offset:3072
    s_waitcnt lgkmcnt(2)
    v_mul_f32 v24, v76, v76
    v_mul_f32 v25, v77, v77
    v_mul_f32 v26, v78, v78
    v_mul_f32 v27, v79, v79
    v_mul_f32 v28, v80, v80
    v_mul_f32 v29, v81, v81
    v_mul_f32 v30, v82, v82
    v_mul_f32 v31, v83, v83
    v_fma_f32 v24, v24, v32, v33
    v_fma_f32 v25, v25, v32, v33
    v_fma_f32 v26, v26, v32, v33
    v_fma_f32 v27, v27, v32, v33
    v_fma_f32 v28, v28, v32, v33
    v_fma_f32 v29, v29, v32, v33
    v_fma_f32 v30, v30, v32, v33
    v_fma_f32 v31, v31, v32, v33
    v_mul_f32 v24, v24, v76
    v_mul_f32 v25, v25, v77
    v_mul_f32 v26, v26, v78
    v_mul_f32 v27, v27, v79
    v_mul_f32 v28, v28, v80
    v_mul_f32 v29, v29, v81
    v_mul_f32 v30, v30, v82
    v_mul_f32 v31, v31, v83
    v_exp_f32 v24, v24
    v_exp_f32 v25, v25
    v_exp_f32 v26, v26
    v_exp_f32 v27, v27
    v_exp_f32 v28, v28
    v_exp_f32 v29, v29
    v_exp_f32 v30, v30
    v_exp_f32 v31, v31
    v_fma_f32 v24, v24, v34, v34
    v_fma_f32 v25, v25, v34, v34
    v_rcp_f32 v24, v24
    v_fma_f32 v26, v26, v34, v34
    v_rcp_f32 v25, v25
    v_fma_f32 v27, v27, v34, v34
    v_rcp_f32 v26, v26
    v_fma_f32 v28, v28, v34, v34
    v_rcp_f32 v27, v27
    v_fma_f32 v29, v29, v34, v34
    v_rcp_f32 v28, v28
    v_fma_f32 v30, v30, v34, v34
    v_rcp_f32 v29, v29
    v_fma_f32 v31, v31, v34, v34
    v_rcp_f32 v30, v30
    v_mul_f32 v24, v24, v76
    v_rcp_f32 v31, v31
    v_mul_f32 v25, v25, v77
    v_mul_f32 v26, v26, v78
    v_mul_f32 v27, v27, v79
    v_mul_f32 v28, v28, v80
    v_mul_f32 v29, v29, v81
    v_mul_f32 v30, v30, v82
    v_mul_f32 v31, v31, v83
    v_cvt_pk_bf16_f32 v16, v24, v25
    v_cvt_pk_bf16_f32 v17, v26, v27
    v_cvt_pk_bf16_f32 v18, v28, v29
    v_cvt_pk_bf16_f32 v19, v30, v31
    buffer_store_dwordx4 v[16:19], v6, s[44:47], s63 offen offset:2048 sc0 sc1
    s_waitcnt lgkmcnt(0)
    v_mul_f32 v24, v84, v84
    v_mul_f32 v25, v85, v85
    v_mul_f32 v26, v86, v86
    v_mul_f32 v27, v87, v87
    v_mul_f32 v28, v88, v88
    v_mul_f32 v29, v89, v89
    v_mul_f32 v30, v90, v90
    v_mul_f32 v31, v91, v91
    v_fma_f32 v24, v24, v32, v33
    v_fma_f32 v25, v25, v32, v33
    v_fma_f32 v26, v26, v32, v33
    v_fma_f32 v27, v27, v32, v33
    v_fma_f32 v28, v28, v32, v33
    v_fma_f32 v29, v29, v32, v33
    v_fma_f32 v30, v30, v32, v33
    v_fma_f32 v31, v31, v32, v33
    v_mul_f32 v24, v24, v84
    v_mul_f32 v25, v25, v85
    v_mul_f32 v26, v26, v86
    v_mul_f32 v27, v27, v87
    v_mul_f32 v28, v28, v88
    v_mul_f32 v29, v29, v89
    v_mul_f32 v30, v30, v90
    v_mul_f32 v31, v31, v91
    v_exp_f32 v24, v24
    v_exp_f32 v25, v25
    v_exp_f32 v26, v26
    v_exp_f32 v27, v27
    v_exp_f32 v28, v28
    v_exp_f32 v29, v29
    v_exp_f32 v30, v30
    v_exp_f32 v31, v31
    v_fma_f32 v24, v24, v34, v34
    v_fma_f32 v25, v25, v34, v34
    v_rcp_f32 v24, v24
    v_fma_f32 v26, v26, v34, v34
    v_rcp_f32 v25, v25
    v_fma_f32 v27, v27, v34, v34
    v_rcp_f32 v26, v26
    v_fma_f32 v28, v28, v34, v34
    v_rcp_f32 v27, v27
    v_fma_f32 v29, v29, v34, v34
    v_rcp_f32 v28, v28
    v_fma_f32 v30, v30, v34, v34
    v_rcp_f32 v29, v29
    v_fma_f32 v31, v31, v34, v34
    v_rcp_f32 v30, v30
    v_mul_f32 v24, v24, v84
    v_rcp_f32 v31, v31
    v_mul_f32 v25, v25, v85
    v_mul_f32 v26, v26, v86
    v_mul_f32 v27, v27, v87
    v_mul_f32 v28, v28, v88
    v_mul_f32 v29, v29, v89
    v_mul_f32 v30, v30, v90
    v_mul_f32 v31, v31, v91
    v_cvt_pk_bf16_f32 v20, v24, v25
    v_cvt_pk_bf16_f32 v21, v26, v27
    v_cvt_pk_bf16_f32 v22, v28, v29
    v_cvt_pk_bf16_f32 v23, v30, v31
    buffer_store_dwordx4 v[20:23], v6, s[44:47], s63 offen offset:3072 sc0 sc1
    s_barrier
    ds_read_b128 v[76:79], v95 offset:0
    ds_read_b128 v[80:83], v95 offset:1024
    ds_read_b128 v[84:87], v95 offset:2048
    ds_read_b128 v[88:91], v95 offset:3072
    s_waitcnt lgkmcnt(2)
    v_mul_f32 v24, v76, v76
    v_mul_f32 v25, v77, v77
    v_mul_f32 v26, v78, v78
    v_mul_f32 v27, v79, v79
    v_mul_f32 v28, v80, v80
    v_mul_f32 v29, v81, v81
    v_mul_f32 v30, v82, v82
    v_mul_f32 v31, v83, v83
    v_fma_f32 v24, v24, v32, v33
    v_fma_f32 v25, v25, v32, v33
    v_fma_f32 v26, v26, v32, v33
    v_fma_f32 v27, v27, v32, v33
    v_fma_f32 v28, v28, v32, v33
    v_fma_f32 v29, v29, v32, v33
    v_fma_f32 v30, v30, v32, v33
    v_fma_f32 v31, v31, v32, v33
    v_mul_f32 v24, v24, v76
    v_mul_f32 v25, v25, v77
    v_mul_f32 v26, v26, v78
    v_mul_f32 v27, v27, v79
    v_mul_f32 v28, v28, v80
    v_mul_f32 v29, v29, v81
    v_mul_f32 v30, v30, v82
    v_mul_f32 v31, v31, v83
    v_exp_f32 v24, v24
    v_exp_f32 v25, v25
    v_exp_f32 v26, v26
    v_exp_f32 v27, v27
    v_exp_f32 v28, v28
    v_exp_f32 v29, v29
    v_exp_f32 v30, v30
    v_exp_f32 v31, v31
    v_fma_f32 v24, v24, v34, v34
    v_fma_f32 v25, v25, v34, v34
    v_rcp_f32 v24, v24
    v_fma_f32 v26, v26, v34, v34
    v_rcp_f32 v25, v25
    v_fma_f32 v27, v27, v34, v34
    v_rcp_f32 v26, v26
    v_fma_f32 v28, v28, v34, v34
    v_rcp_f32 v27, v27
    v_fma_f32 v29, v29, v34, v34
    v_rcp_f32 v28, v28
    v_fma_f32 v30, v30, v34, v34
    v_rcp_f32 v29, v29
    v_fma_f32 v31, v31, v34, v34
    v_rcp_f32 v30, v30
    v_mul_f32 v24, v24, v76
    v_rcp_f32 v31, v31
    v_mul_f32 v25, v25, v77
    v_mul_f32 v26, v26, v78
    v_mul_f32 v27, v27, v79
    v_mul_f32 v28, v28, v80
    v_mul_f32 v29, v29, v81
    v_mul_f32 v30, v30, v82
    v_mul_f32 v31, v31, v83
    v_cvt_pk_bf16_f32 v16, v24, v25
    v_cvt_pk_bf16_f32 v17, v26, v27
    v_cvt_pk_bf16_f32 v18, v28, v29
    v_cvt_pk_bf16_f32 v19, v30, v31
    buffer_store_dwordx4 v[16:19], v6, s[44:47], s64 offen offset:0 sc0 sc1
    s_waitcnt lgkmcnt(0)
    v_mul_f32 v24, v84, v84
    v_mul_f32 v25, v85, v85
    v_mul_f32 v26, v86, v86
    v_mul_f32 v27, v87, v87
    v_mul_f32 v28, v88, v88
    v_mul_f32 v29, v89, v89
    v_mul_f32 v30, v90, v90
    v_mul_f32 v31, v91, v91
    v_fma_f32 v24, v24, v32, v33
    v_fma_f32 v25, v25, v32, v33
    v_fma_f32 v26, v26, v32, v33
    v_fma_f32 v27, v27, v32, v33
    v_fma_f32 v28, v28, v32, v33
    v_fma_f32 v29, v29, v32, v33
    v_fma_f32 v30, v30, v32, v33
    v_fma_f32 v31, v31, v32, v33
    v_mul_f32 v24, v24, v84
    v_mul_f32 v25, v25, v85
    v_mul_f32 v26, v26, v86
    v_mul_f32 v27, v27, v87
    v_mul_f32 v28, v28, v88
    v_mul_f32 v29, v29, v89
    v_mul_f32 v30, v30, v90
    v_mul_f32 v31, v31, v91
    v_exp_f32 v24, v24
    v_exp_f32 v25, v25
    v_exp_f32 v26, v26
    v_exp_f32 v27, v27
    v_exp_f32 v28, v28
    v_exp_f32 v29, v29
    v_exp_f32 v30, v30
    v_exp_f32 v31, v31
    v_fma_f32 v24, v24, v34, v34
    v_fma_f32 v25, v25, v34, v34
    v_rcp_f32 v24, v24
    v_fma_f32 v26, v26, v34, v34
    v_rcp_f32 v25, v25
    v_fma_f32 v27, v27, v34, v34
    v_rcp_f32 v26, v26
    v_fma_f32 v28, v28, v34, v34
    v_rcp_f32 v27, v27
    v_fma_f32 v29, v29, v34, v34
    v_rcp_f32 v28, v28
    v_fma_f32 v30, v30, v34, v34
    v_rcp_f32 v29, v29
    v_fma_f32 v31, v31, v34, v34
    v_rcp_f32 v30, v30
    v_mul_f32 v24, v24, v84
    v_rcp_f32 v31, v31
    v_mul_f32 v25, v25, v85
    v_mul_f32 v26, v26, v86
    v_mul_f32 v27, v27, v87
    v_mul_f32 v28, v28, v88
    v_mul_f32 v29, v29, v89
    v_mul_f32 v30, v30, v90
    v_mul_f32 v31, v31, v91
    v_cvt_pk_bf16_f32 v20, v24, v25
    v_cvt_pk_bf16_f32 v21, v26, v27
    v_cvt_pk_bf16_f32 v22, v28, v29
    v_cvt_pk_bf16_f32 v23, v30, v31
    buffer_store_dwordx4 v[20:23], v6, s[44:47], s64 offen offset:1024 sc0 sc1
    s_barrier
    ds_read_b128 v[76:79], v2 offset:0
    ds_read_b128 v[80:83], v2 offset:1024
    s_waitcnt lgkmcnt(0)
    v_pk_mul_f32 v[24:25], v[76:77], v[76:77]
    v_pk_mul_f32 v[26:27], v[78:79], v[78:79]
    v_pk_fma_f32 v[24:25], v[24:25], v[32:33], v[32:33] op_sel:[0,0,1] op_sel_hi:[1,0,1]
    v_pk_fma_f32 v[26:27], v[26:27], v[32:33], v[32:33] op_sel:[0,0,1] op_sel_hi:[1,0,1]
    v_pk_mul_f32 v[24:25], v[24:25], v[76:77]
    v_pk_mul_f32 v[26:27], v[26:27], v[78:79]
    v_exp_f32 v24, v24
    v_exp_f32 v25, v25
    v_exp_f32 v26, v26
    v_exp_f32 v27, v27
    v_pk_fma_f32 v[24:25], v[24:25], v[34:35], v[34:35] op_sel_hi:[1,0,0]
    v_pk_fma_f32 v[26:27], v[26:27], v[34:35], v[34:35] op_sel_hi:[1,0,0]
    v_rcp_f32 v24, v24
    v_rcp_f32 v25, v25
    v_rcp_f32 v26, v26
    v_rcp_f32 v27, v27
    v_pk_mul_f32 v[24:25], v[24:25], v[76:77]
    v_pk_mul_f32 v[26:27], v[26:27], v[78:79]
    v_cvt_pk_bf16_f32 v16, v24, v25
    v_cvt_pk_bf16_f32 v17, v26, v27
    v_pk_mul_f32 v[28:29], v[80:81], v[80:81]
    v_pk_mul_f32 v[30:31], v[82:83], v[82:83]
    v_pk_fma_f32 v[28:29], v[28:29], v[32:33], v[32:33] op_sel:[0,0,1] op_sel_hi:[1,0,1]
    v_pk_fma_f32 v[30:31], v[30:31], v[32:33], v[32:33] op_sel:[0,0,1] op_sel_hi:[1,0,1]
    v_pk_mul_f32 v[28:29], v[28:29], v[80:81]
    v_pk_mul_f32 v[30:31], v[30:31], v[82:83]
    v_exp_f32 v28, v28
    v_exp_f32 v29, v29
    v_exp_f32 v30, v30
    v_exp_f32 v31, v31
    v_pk_fma_f32 v[28:29], v[28:29], v[34:35], v[34:35] op_sel_hi:[1,0,0]
    v_pk_fma_f32 v[30:31], v[30:31], v[34:35], v[34:35] op_sel_hi:[1,0,0]
    v_rcp_f32 v28, v28
    v_rcp_f32 v29, v29
    v_rcp_f32 v30, v30
    v_rcp_f32 v31, v31
    v_pk_mul_f32 v[28:29], v[28:29], v[80:81]
    v_pk_mul_f32 v[30:31], v[30:31], v[82:83]
    v_cvt_pk_bf16_f32 v18, v28, v29
    v_cvt_pk_bf16_f32 v19, v30, v31
    buffer_store_dwordx4 v[16:19], v6, s[44:47], s64 offen offset:2048 sc0 sc1
    s_endpgm
k1_kernel_misc:
    s_nop 4
    s_cmp_ge_u32 s3, 4
    s_cbranch_scc1 k1_kernel_pf
    s_sub_u32 s4, s2, 224
    s_and_b32 s5, s4, 3
    s_lshr_b32 s6, s4, 2
    v_lshlrev_b32 v6, 4, v1
    s_waitcnt lgkmcnt(0)
    s_mov_b32 s36, s18
    s_and_b32 s37, s19, 0xffff
    s_mov_b32 s38, 921600
    s_mov_b32 s39, 0x00020000
    s_mov_b32 s40, s20
    s_and_b32 s41, s21, 0xffff
    s_mov_b32 s42, 921600
    s_mov_b32 s43, 0x00020000
    s_mov_b32 s44, s34
    s_and_b32 s45, s35, 0xffff
    s_mov_b32 s46, 268435456
    s_mov_b32 s47, 0x00020000
    s_lshl_b32 s7, s6, 2
    s_add_u32 s7, s7, s3
    s_lshl_b32 s7, s7, 2
    s_add_u32 s7, s7, s5
    s_mul_i32 s7, s7, 7200
    s_lshl_b32 s8, s3, 13
    s_sleep 24
    s_add_u32 m0, s8, 0
    s_add_u32 s9, s7, 0
    buffer_load_dwordx4 v6, s[36:39], s9 offen lds
    s_add_u32 m0, s8, 1024
    s_add_u32 s9, s7, 1024
    buffer_load_dwordx4 v6, s[36:39], s9 offen lds
    s_add_u32 m0, s8, 2048
    s_add_u32 s9, s7, 2048
    buffer_load_dwordx4 v6, s[36:39], s9 offen lds
    s_add_u32 m0, s8, 3072
    s_add_u32 s9, s7, 3072
    buffer_load_dwordx4 v6, s[36:39], s9 offen lds
    s_add_u32 m0, s8, 4096
    s_add_u32 s9, s7, 4096
    buffer_load_dwordx4 v6, s[36:39], s9 offen lds
    s_add_u32 m0, s8, 5120
    s_add_u32 s9, s7, 5120
    buffer_load_dwordx4 v6, s[36:39], s9 offen lds
    s_add_u32 m0, s8, 6144
    s_add_u32 s9, s7, 6144
    buffer_load_dwordx4 v6, s[36:39], s9 offen lds
    s_add_u32 m0, s8, 7168
    s_add_u32 s9, s7, 7168
    buffer_load_dwordx4 v6, s[36:39], s9 offen lds
    s_add_u32 m0, s8, 32768
    s_add_u32 s9, s7, 0
    buffer_load_dwordx4 v6, s[40:43], s9 offen lds
    s_add_u32 m0, s8, 33792
    s_add_u32 s9, s7, 1024
    buffer_load_dwordx4 v6, s[40:43], s9 offen lds
    s_add_u32 m0, s8, 34816
    s_add_u32 s9, s7, 2048
    buffer_load_dwordx4 v6, s[40:43], s9 offen lds
    s_add_u32 m0, s8, 35840
    s_add_u32 s9, s7, 3072
    buffer_load_dwordx4 v6, s[40:43], s9 offen lds
    s_add_u32 m0, s8, 36864
    s_add_u32 s9, s7, 4096
    buffer_load_dwordx4 v6, s[40:43], s9 offen lds
    s_add_u32 m0, s8, 37888
    s_add_u32 s9, s7, 5120
    buffer_load_dwordx4 v6, s[40:43], s9 offen lds
    s_add_u32 m0, s8, 38912
    s_add_u32 s9, s7, 6144
    buffer_load_dwordx4 v6, s[40:43], s9 offen lds
    s_add_u32 m0, s8, 39936
    s_add_u32 s9, s7, 7168
    buffer_load_dwordx4 v6, s[40:43], s9 offen lds
    s_lshl_b32 s10, s4, 2
    s_add_u32 s10, s10, s3
    v_and_b32 v7, 15, v1
    v_lshrrev_b32 v8, 4, v1
    v_mul_u32_u24 v9, 450, v7
    s_lshl_b32 s11, s3, 2
    v_add_u32 v2, s11, v8
    v_lshl_add_u32 v9, v2, 1, v9
    v_lshlrev_b32 v10, 13, v2
    v_lshl_add_u32 v10, v7, 4, v10
    s_lshl_b32 s12, s5, 11
    s_lshl_b32 s13, s6, 8
    s_add_u32 s12, s12, s13
    s_add_u32 s12, s12, 16515072
    v_cmp_eq_u32 vcc, 0, v2
    v_mov_b32 v3, 268435456
    s_waitcnt vmcnt(0)
    s_barrier
    ds_read_u16 v16, v9 offset:0
    ds_read_u16 v20, v9 offset:32768
    ds_read_u16 v17, v9 offset:8192
    ds_read_u16 v21, v9 offset:40960
    ds_read_u16 v18, v9 offset:16384
    ds_read_u16 v22, v9 offset:49152
    ds_read_u16 v19, v9 offset:24576
    ds_read_u16 v23, v9 offset:57344
    s_waitcnt lgkmcnt(0)
    ds_read_u16 v24, v9 offset:32
    ds_read_u16 v28, v9 offset:32800
    ds_read_u16 v25, v9 offset:8224
    ds_read_u16 v29, v9 offset:40992
    ds_read_u16 v26, v9 offset:16416
    ds_read_u16 v30, v9 offset:49184
    ds_read_u16 v27, v9 offset:24608
    ds_read_u16 v31, v9 offset:57376
    v_lshl_or_b32 v12, v20, 16, v16
    v_lshl_or_b32 v13, v21, 16, v17
    v_lshl_or_b32 v14, v22, 16, v18
    v_lshl_or_b32 v15, v23, 16, v19
    buffer_store_dwordx4 v[12:15], v10, s[44:47], s12 offen
    s_add_u32 s12, s12, 131072
    s_waitcnt lgkmcnt(0)
    ds_read_u16 v16, v9 offset:64
    ds_read_u16 v20, v9 offset:32832
    ds_read_u16 v17, v9 offset:8256
    ds_read_u16 v21, v9 offset:41024
    ds_read_u16 v18, v9 offset:16448
    ds_read_u16 v22, v9 offset:49216
    ds_read_u16 v19, v9 offset:24640
    ds_read_u16 v23, v9 offset:57408
    v_lshl_or_b32 v44, v28, 16, v24
    v_lshl_or_b32 v45, v29, 16, v25
    v_lshl_or_b32 v46, v30, 16, v26
    v_lshl_or_b32 v47, v31, 16, v27
    buffer_store_dwordx4 v[44:47], v10, s[44:47], s12 offen
    s_add_u32 s12, s12, 131072
    s_waitcnt lgkmcnt(0)
    ds_read_u16 v24, v9 offset:96
    ds_read_u16 v28, v9 offset:32864
    ds_read_u16 v25, v9 offset:8288
    ds_read_u16 v29, v9 offset:41056
    ds_read_u16 v26, v9 offset:16480
    ds_read_u16 v30, v9 offset:49248
    ds_read_u16 v27, v9 offset:24672
    ds_read_u16 v31, v9 offset:57440
    v_lshl_or_b32 v12, v20, 16, v16
    v_lshl_or_b32 v13, v21, 16, v17
    v_lshl_or_b32 v14, v22, 16, v18
    v_lshl_or_b32 v15, v23, 16, v19
    buffer_store_dwordx4 v[12:15], v10, s[44:47], s12 offen
    s_add_u32 s12, s12, 131072
    s_waitcnt lgkmcnt(0)
    ds_read_u16 v16, v9 offset:128
    ds_read_u16 v20, v9 offset:32896
    ds_read_u16 v17, v9 offset:8320
    ds_read_u16 v21, v9 offset:41088
    ds_read_u16 v18, v9 offset:16512
    ds_read_u16 v22, v9 offset:49280
    ds_read_u16 v19, v9 offset:24704
    ds_read_u16 v23, v9 offset:57472
    v_lshl_or_b32 v44, v28, 16, v24
    v_lshl_or_b32 v45, v29, 16, v25
    v_lshl_or_b32 v46, v30, 16, v26
    v_lshl_or_b32 v47, v31, 16, v27
    buffer_store_dwordx4 v[44:47], v10, s[44:47], s12 offen
    s_add_u32 s12, s12, 131072
    s_waitcnt lgkmcnt(0)
    ds_read_u16 v24, v9 offset:160
    ds_read_u16 v28, v9 offset:32928
    ds_read_u16 v25, v9 offset:8352
    ds_read_u16 v29, v9 offset:41120
    ds_read_u16 v26, v9 offset:16544
    ds_read_u16 v30, v9 offset:49312
    ds_read_u16 v27, v9 offset:24736
    ds_read_u16 v31, v9 offset:57504
    v_lshl_or_b32 v12, v20, 16, v16
    v_lshl_or_b32 v13, v21, 16, v17
    v_lshl_or_b32 v14, v22, 16, v18
    v_lshl_or_b32 v15, v23, 16, v19
    buffer_store_dwordx4 v[12:15], v10, s[44:47], s12 offen
    s_add_u32 s12, s12, 131072
    s_waitcnt lgkmcnt(0)
    ds_read_u16 v16, v9 offset:192
    ds_read_u16 v20, v9 offset:32960
    ds_read_u16 v17, v9 offset:8384
    ds_read_u16 v21, v9 offset:41152
    ds_read_u16 v18, v9 offset:16576
    ds_read_u16 v22, v9 offset:49344
    ds_read_u16 v19, v9 offset:24768
    ds_read_u16 v23, v9 offset:57536
    v_lshl_or_b32 v44, v28, 16, v24
    v_lshl_or_b32 v45, v29, 16, v25
    v_lshl_or_b32 v46, v30, 16, v26
    v_lshl_or_b32 v47, v31, 16, v27
    buffer_store_dwordx4 v[44:47], v10, s[44:47], s12 offen
    s_add_u32 s12, s12, 131072
    s_waitcnt lgkmcnt(0)
    ds_read_u16 v24, v9 offset:224
    ds_read_u16 v28, v9 offset:32992
    ds_read_u16 v25, v9 offset:8416
    ds_read_u16 v29, v9 offset:41184
    ds_read_u16 v26, v9 offset:16608
    ds_read_u16 v30, v9 offset:49376
    ds_read_u16 v27, v9 offset:24800
    ds_read_u16 v31, v9 offset:57568
    v_lshl_or_b32 v12, v20, 16, v16
    v_lshl_or_b32 v13, v21, 16, v17
    v_lshl_or_b32 v14, v22, 16, v18
    v_lshl_or_b32 v15, v23, 16, v19
    buffer_store_dwordx4 v[12:15], v10, s[44:47], s12 offen
    s_add_u32 s12, s12, 131072
    s_waitcnt lgkmcnt(0)
    ds_read_u16 v16, v9 offset:256
    ds_read_u16 v20, v9 offset:33024
    ds_read_u16 v17, v9 offset:8448
    ds_read_u16 v21, v9 offset:41216
    ds_read_u16 v18, v9 offset:16640
    ds_read_u16 v22, v9 offset:49408
    ds_read_u16 v19, v9 offset:24832
    ds_read_u16 v23, v9 offset:57600
    v_lshl_or_b32 v44, v28, 16, v24
    v_lshl_or_b32 v45, v29, 16, v25
    v_lshl_or_b32 v46, v30, 16, v26
    v_lshl_or_b32 v47, v31, 16, v27
    buffer_store_dwordx4 v[44:47], v10, s[44:47], s12 offen
    s_add_u32 s12, s12, 131072
    s_waitcnt lgkmcnt(0)
    ds_read_u16 v24, v9 offset:288
    ds_read_u16 v28, v9 offset:33056
    ds_read_u16 v25, v9 offset:8480
    ds_read_u16 v29, v9 offset:41248
    ds_read_u16 v26, v9 offset:16672
    ds_read_u16 v30, v9 offset:49440
    ds_read_u16 v27, v9 offset:24864
    ds_read_u16 v31, v9 offset:57632
    v_lshl_or_b32 v12, v20, 16, v16
    v_lshl_or_b32 v13, v21, 16, v17
    v_lshl_or_b32 v14, v22, 16, v18
    v_lshl_or_b32 v15, v23, 16, v19
    buffer_store_dwordx4 v[12:15], v10, s[44:47], s12 offen
    s_add_u32 s12, s12, 131072
    s_waitcnt lgkmcnt(0)
    ds_read_u16 v16, v9 offset:320
    ds_read_u16 v20, v9 offset:33088
    ds_read_u16 v17, v9 offset:8512
    ds_read_u16 v21, v9 offset:41280
    ds_read_u16 v18, v9 offset:16704
    ds_read_u16 v22, v9 offset:49472
    ds_read_u16 v19, v9 offset:24896
    ds_read_u16 v23, v9 offset:57664
    v_lshl_or_b32 v44, v28, 16, v24
    v_lshl_or_b32 v45, v29, 16, v25
    v_lshl_or_b32 v46, v30, 16, v26
    v_lshl_or_b32 v47, v31, 16, v27
    buffer_store_dwordx4 v[44:47], v10, s[44:47], s12 offen
    s_add_u32 s12, s12, 131072
    s_waitcnt lgkmcnt(0)
    ds_read_u16 v24, v9 offset:352
    ds_read_u16 v28, v9 offset:33120
    ds_read_u16 v25, v9 offset:8544
    ds_read_u16 v29, v9 offset:41312
    ds_read_u16 v26, v9 offset:16736
    ds_read_u16 v30, v9 offset:49504
    ds_read_u16 v27, v9 offset:24928
    ds_read_u16 v31, v9 offset:57696
    v_lshl_or_b32 v12, v20, 16, v16
    v_lshl_or_b32 v13, v21, 16, v17
    v_lshl_or_b32 v14, v22, 16, v18
    v_lshl_or_b32 v15, v23, 16, v19
    buffer_store_dwordx4 v[12:15], v10, s[44:47], s12 offen
    s_add_u32 s12, s12, 131072
    s_waitcnt lgkmcnt(0)
    ds_read_u16 v16, v9 offset:384
    ds_read_u16 v20, v9 offset:33152
    ds_read_u16 v17, v9 offset:8576
    ds_read_u16 v21, v9 offset:41344
    ds_read_u16 v18, v9 offset:16768
    ds_read_u16 v22, v9 offset:49536
    ds_read_u16 v19, v9 offset:24960
    ds_read_u16 v23, v9 offset:57728
    v_lshl_or_b32 v44, v28, 16, v24
    v_lshl_or_b32 v45, v29, 16, v25
    v_lshl_or_b32 v46, v30, 16, v26
    v_lshl_or_b32 v47, v31, 16, v27
    buffer_store_dwordx4 v[44:47], v10, s[44:47], s12 offen
    s_add_u32 s12, s12, 131072
    s_waitcnt lgkmcnt(0)
    ds_read_u16 v24, v9 offset:416
    ds_read_u16 v28, v9 offset:33184
    ds_read_u16 v25, v9 offset:8608
    ds_read_u16 v29, v9 offset:41376
    ds_read_u16 v26, v9 offset:16800
    ds_read_u16 v30, v9 offset:49568
    ds_read_u16 v27, v9 offset:24992
    ds_read_u16 v31, v9 offset:57760
    v_lshl_or_b32 v12, v20, 16, v16
    v_lshl_or_b32 v13, v21, 16, v17
    v_lshl_or_b32 v14, v22, 16, v18
    v_lshl_or_b32 v15, v23, 16, v19
    buffer_store_dwordx4 v[12:15], v10, s[44:47], s12 offen
    s_add_u32 s12, s12, 131072
    s_waitcnt lgkmcnt(0)
    ds_read_u16 v16, v9 offset:448
    ds_read_u16 v20, v9 offset:33216
    ds_read_u16 v17, v9 offset:8640
    ds_read_u16 v21, v9 offset:41408
    ds_read_u16 v18, v9 offset:16832
    ds_read_u16 v22, v9 offset:49600
    ds_read_u16 v19, v9 offset:25024
    ds_read_u16 v23, v9 offset:57792
    v_lshl_or_b32 v44, v28, 16, v24
    v_lshl_or_b32 v45, v29, 16, v25
    v_lshl_or_b32 v46, v30, 16, v26
    v_lshl_or_b32 v47, v31, 16, v27
    buffer_store_dwordx4 v[44:47], v10, s[44:47], s12 offen
    s_add_u32 s12, s12, 131072
    s_waitcnt lgkmcnt(0)
    v_lshl_or_b32 v12, v20, 16, v16
    v_lshl_or_b32 v13, v21, 16, v17
    v_lshl_or_b32 v14, v22, 16, v18
    v_lshl_or_b32 v15, v23, 16, v19
    v_cndmask_b32 v10, v3, v10, vcc
    buffer_store_dwordx4 v[12:15], v10, s[44:47], s12 offen
    s_add_u32 s12, s12, 131072
    s_endpgm
k1_kernel_pf:
    s_sub_u32 s4, s2, 224
    s_lshl_b32 s4, s4, 2
    s_add_u32 s4, s4, s3
    s_sub_u32 s4, s4, 4
    s_mul_i32 s11, s4, 13312
    v_lshlrev_b32 v6, 4, v1
    v_add_u32 v6, s11, v6
    s_waitcnt lgkmcnt(0)
    s_mov_b32 s36, s28
    s_and_b32 s37, s29, 0xffff
    s_mov_b32 s38, 1605632
    s_mov_b32 s39, 0x00020000
    s_mov_b32 s44, s34
    s_and_b32 s45, s35, 0xffff
    s_mov_b32 s46, 268435456
    s_mov_b32 s47, 0x00020000
    s_lshr_b32 s5, s4, 1
    s_mul_i32 s5, s5, 229376
    s_and_b32 s6, s4, 1
    s_mul_i32 s6, s6, 57344
    s_add_u32 s5, s5, s6
    v_lshlrev_b32 v9, 7, v1
    s_barrier
    s_sleep 40
    buffer_load_dwordx4 v[12:15], v6, s[36:39], 0 offen offset:0
    buffer_load_dwordx4 v[12:15], v6, s[36:39], 0 offen offset:1024
    buffer_load_dwordx4 v[12:15], v6, s[36:39], 0 offen offset:2048
    buffer_load_dwordx4 v[12:15], v6, s[36:39], 0 offen offset:3072
    v_add_u32 v6, 4096, v6
    buffer_load_dwordx4 v[12:15], v6, s[36:39], 0 offen offset:0
    buffer_load_dwordx4 v[12:15], v6, s[36:39], 0 offen offset:1024
    buffer_load_dwordx4 v[12:15], v6, s[36:39], 0 offen offset:2048
    buffer_load_dwordx4 v[12:15], v6, s[36:39], 0 offen offset:3072
    v_add_u32 v6, 4096, v6
    buffer_load_dwordx4 v[12:15], v6, s[36:39], 0 offen offset:0
    buffer_load_dwordx4 v[12:15], v6, s[36:39], 0 offen offset:1024
    buffer_load_dwordx4 v[12:15], v6, s[36:39], 0 offen offset:2048
    buffer_load_dwordx4 v[12:15], v6, s[36:39], 0 offen offset:3072
    v_add_u32 v6, 4096, v6
    buffer_load_dwordx4 v[12:15], v6, s[36:39], 0 offen offset:0
    s_mov_b32 s48, s30
    s_and_b32 s49, s31, 0xffff
    s_mov_b32 s50, 896
    s_mov_b32 s51, 0x00020000
    s_mov_b32 s52, s32
    s_and_b32 s53, s33, 0xffff
    s_mov_b32 s54, 1835008
    s_mov_b32 s55, 0x00020000
    s_and_b32 s6, s2, 7
    s_mul_i32 s6, s6, 3584
    v_mul_u32_u24 v11, 28672, v1
    v_add_u32 v11, s6, v11
    buffer_load_dword v10, v11, s[52:55], 0 offen
    buffer_load_dword v8, v9, s[48:51], 0 offen
k1_kernel_end:
    s_endpgm
.globl k2_kernel
.p2align 8
.type k2_kernel,@function
k2_kernel:
    s_cmp_ge_u32 s2, 256
    s_cbranch_scc1 k2_kernel_end
    s_load_dwordx16 s[16:31], s[0:1], 0
    s_load_dwordx2 s[32:33], s[0:1], 64
    s_load_dwordx2 s[34:35], s[0:1], 80
    s_getpc_b64 s[36:37]
k2_kernel_pc:
    v_lshlrev_b32 v231, 7, v0
    v_min_u32 v231, code_end-k2_kernel_pc-4, v231
    global_load_dword v231, v231, s[36:37]
    v_lshrrev_b32 v2, 6, v0
    v_and_b32 v1, 63, v0
    v_readfirstlane_b32 s3, v2
    s_nop 3
    s_cmp_ge_u32 s3, 4
    s_cbranch_scc1 k2_fft
    s_bfe_u32 s4, s2, 0x20001
    s_and_b32 s5, s2, 1
    s_bfe_u32 s6, s2, 0x30003
    s_lshr_b32 s7, s2, 6
    s_lshl_b32 s8, s5, 3
    s_add_u32 s8, s8, s6
    s_lshl_b32 s8, s8, 2
    s_add_u32 s8, s8, s3
    v_lshrrev_b32 v2, 3, v1
    v_and_b32 v3, 7, v1
    v_lshlrev_b32 v4, 1, v2
    v_and_b32 v4, 4, v4
    v_xor_b32 v4, v4, v3
    v_lshlrev_b32 v4, 4, v4
    v_mul_u32_u24 v6, 896, v2
    v_add_u32 v6, v6, v4
    v_lshlrev_b32 v5, 4, v1
    s_lshl_b32 s9, s7, 2
    s_min_u32 s9, s9, 10
    s_mul_i32 s10, s4, 401408
    s_mul_i32 s11, s3, 14336
    s_add_u32 s10, s10, s11
    s_lshl_b32 s11, s9, 6
    s_add_u32 s10, s10, s11
    s_mul_i32 s11, s8, 229376
    s_mul_i32 s12, s4, 28672
    s_add_u32 s11, s11, s12
    s_lshl_b32 s57, s3, 12
    s_mul_i32 s62, s6, 0
    s_mul_i32 s63, s7, 0
    s_add_u32 s62, s62, s63
    s_mul_i32 s63, s62, 57344
    s_add_u32 s63, s63, s10
    s_lshl_b32 s64, s62, 12
    s_add_u32 s64, s64, s11
    s_waitcnt lgkmcnt(0)
    s_mov_b32 s44, s34
    s_and_b32 s45, s35, 0xffff
    s_mov_b32 s46, 268435456
    s_mov_b32 s47, 0x00020000
    s_mov_b32 s40, s28
    s_and_b32 s41, s29, 0xffff
    s_mov_b32 s42, 1605632
    s_mov_b32 s43, 0x00020000
    s_add_u32 m0, s57, 0
    s_nop 0
    buffer_load_dwordx4 v6, s[40:43], s63 offen lds
    s_add_u32 m0, s57, 2048
    s_add_u32 s58, s63, 128
    buffer_load_dwordx4 v6, s[40:43], s58 offen lds
    s_add_u32 m0, s57, 1024
    s_add_u32 s58, s63, 7168
    buffer_load_dwordx4 v6, s[40:43], s58 offen lds
    s_add_u32 m0, s57, 3072
    s_add_u32 s58, s63, 7296
    buffer_load_dwordx4 v6, s[40:43], s58 offen lds
    buffer_load_dwordx4 v[108:111], v5, s[44:47], s64 offen offset:0
    buffer_load_dwordx4 v[112:115], v5, s[44:47], s64 offen offset:1024
    buffer_load_dwordx4 v[116:119], v5, s[44:47], s64 offen offset:2048
    buffer_load_dwordx4 v[120:123], v5, s[44:47], s64 offen offset:3072
    s_add_u32 s62, s62, 1
    s_add_u32 s63, s63, 57344
    s_add_u32 s64, s64, 4096
    s_cmp_eq_u32 s62, 7
    s_cselect_b32 s62, 0, s62
    s_cselect_b32 s63, s10, s63
    s_cselect_b32 s64, s11, s64
    s_add_u32 m0, s57, 16384
    s_nop 0
    buffer_load_dwordx4 v6, s[40:43], s63 offen lds
    s_add_u32 m0, s57, 18432
    s_add_u32 s58, s63, 128
    buffer_load_dwordx4 v6, s[40:43], s58 offen lds
    s_add_u32 m0, s57, 17408
    s_add_u32 s58, s63, 7168
    buffer_load_dwordx4 v6, s[40:43], s58 offen lds
    s_add_u32 m0, s57, 19456
    s_add_u32 s58, s63, 7296
    buffer_load_dwordx4 v6, s[40:43], s58 offen lds
    buffer_load_dwordx4 v[124:127], v5, s[44:47], s64 offen offset:0
    buffer_load_dwordx4 v[128:131], v5, s[44:47], s64 offen offset:1024
    buffer_load_dwordx4 v[132:135], v5, s[44:47], s64 offen offset:2048
    buffer_load_dwordx4 v[136:139], v5, s[44:47], s64 offen offset:3072
    s_add_u32 s62, s62, 1
    s_add_u32 s63, s63, 57344
    s_add_u32 s64, s64, 4096
    s_cmp_eq_u32 s62, 7
    s_cselect_b32 s62, 0, s62
    s_cselect_b32 s63, s10, s63
    s_cselect_b32 s64, s11, s64
    s_lshl_b32 s60, s4, 6
    s_add_u32 s60, s60, s8
    s_mul_i32 s60, s60, 14
    s_add_u32 s60, s60, s9
    s_lshl_b32 s60, s60, 11
    s_add_u32 s60, s60, 18780160
    s_lshl_b32 s60, s9, 11
    s_add_u32 s60, s60, s11
    s_add_u32 s60, s60, 114688
    s_add_u32 s61, s60, 4096
    v_bfe_u32 v2, v1, 2, 2
    v_lshrrev_b32 v3, 5, v1
    v_lshl_add_u32 v2, v3, 2, v2
    v_lshlrev_b32 v2, 7, v2
    v_bfe_u32 v3, v1, 3, 1
    v_lshl_add_u32 v2, v3, 6, v2
    v_bfe_u32 v3, v1, 4, 1
    v_lshl_add_u32 v2, v3, 5, v2
    v_and_b32 v3, 3, v1
    v_lshl_add_u32 v7, v3, 3, v2
    v_xor_b32 v8, 64, v7
    v_add_u32 v9, 65536, v7
    v_add_u32 v10, 65536, v8
    s_waitcnt vmcnt(12)
    s_barrier
    ds_read_b64_tr_b16 v[76:77], v7 offset:0
    ds_read_b64_tr_b16 v[78:79], v7 offset:1024
    ds_read_b64_tr_b16 v[80:81], v8 offset:0
    ds_read_b64_tr_b16 v[82:83], v8 offset:1024
    ds_read_b64_tr_b16 v[84:85], v7 offset:2048
    ds_read_b64_tr_b16 v[86:87], v7 offset:3072
    ds_read_b64_tr_b16 v[88:89], v8 offset:2048
    ds_read_b64_tr_b16 v[90:91], v8 offset:3072
    ds_read_b64_tr_b16 v[92:93], v7 offset:4096
    ds_read_b64_tr_b16 v[94:95], v7 offset:5120
    ds_read_b64_tr_b16 v[96:97], v8 offset:4096
    ds_read_b64_tr_b16 v[98:99], v8 offset:5120
    ds_read_b64_tr_b16 v[100:101], v7 offset:6144
    ds_read_b64_tr_b16 v[102:103], v7 offset:7168
    s_waitcnt lgkmcnt(10)
    s_waitcnt vmcnt(11)
    v_mfma_f32_32x32x16_bf16 v[12:27], v[76:79], v[108:111], 0
    s_add_u32 m0, s57, 32768
    s_nop 0
    buffer_load_dwordx4 v6, s[40:43], s63 offen lds
    ds_read_b64_tr_b16 v[104:105], v8 offset:6144
    ds_read_b64_tr_b16 v[106:107], v8 offset:7168
    v_mfma_f32_32x32x16_bf16 v[28:43], v[80:83], v[108:111], 0
    s_add_u32 m0, s57, 34816
    s_add_u32 s58, s63, 128
    buffer_load_dwordx4 v6, s[40:43], s58 offen lds
    ds_read_b64_tr_b16 v[76:77], v7 offset:8192
    ds_read_b64_tr_b16 v[78:79], v7 offset:9216
    s_waitcnt lgkmcnt(10)
    v_mfma_f32_32x32x16_bf16 v[44:59], v[84:87], v[108:111], 0
    s_add_u32 m0, s57, 33792
    s_add_u32 s58, s63, 7168
    buffer_load_dwordx4 v6, s[40:43], s58 offen lds
    ds_read_b64_tr_b16 v[80:81], v8 offset:8192
    ds_read_b64_tr_b16 v[82:83], v8 offset:9216
    v_mfma_f32_32x32x16_bf16 v[60:75], v[88:91], v[108:111], 0
    s_add_u32 m0, s57, 35840
    s_add_u32 s58, s63, 7296
    buffer_load_dwordx4 v6, s[40:43], s58 offen lds
    ds_read_b64_tr_b16 v[84:85], v7 offset:10240
    ds_read_b64_tr_b16 v[86:87], v7 offset:11264
    s_waitcnt lgkmcnt(10)
    s_waitcnt vmcnt(14)
    v_mfma_f32_32x32x16_bf16 v[12:27], v[92:95], v[112:115], v[12:27]
    buffer_load_dwordx4 v[140:143], v5, s[44:47], s64 offen offset:0
    ds_read_b64_tr_b16 v[88:89], v8 offset:10240
    ds_read_b64_tr_b16 v[90:91], v8 offset:11264
    v_mfma_f32_32x32x16_bf16 v[28:43], v[96:99], v[112:115], v[28:43]
    buffer_load_dwordx4 v[144:147], v5, s[44:47], s64 offen offset:1024
    ds_read_b64_tr_b16 v[92:93], v7 offset:12288
    ds_read_b64_tr_b16 v[94:95], v7 offset:13312
    s_waitcnt lgkmcnt(10)
    v_mfma_f32_32x32x16_bf16 v[44:59], v[100:103], v[112:115], v[44:59]
    buffer_load_dwordx4 v[148:151], v5, s[44:47], s64 offen offset:2048
    ds_read_b64_tr_b16 v[96:97], v8 offset:12288
    ds_read_b64_tr_b16 v[98:99], v8 offset:13312
    v_mfma_f32_32x32x16_bf16 v[60:75], v[104:107], v[112:115], v[60:75]
    buffer_load_dwordx4 v[152:155], v5, s[44:47], s64 offen offset:3072
    s_add_u32 s62, s62, 1
    s_add_u32 s63, s63, 57344
    s_add_u32 s64, s64, 4096
    s_cmp_eq_u32 s62, 7
    s_cselect_b32 s62, 0, s62
    s_cselect_b32 s63, s10, s63
    s_cselect_b32 s64, s11, s64
    ds_read_b64_tr_b16 v[100:101], v7 offset:14336
    ds_read_b64_tr_b16 v[102:103], v7 offset:15360
    s_waitcnt lgkmcnt(10)
    s_waitcnt vmcnt(17)
    v_mfma_f32_32x32x16_bf16 v[12:27], v[76:79], v[116:119], v[12:27]
    ds_read_b64_tr_b16 v[104:105], v8 offset:14336
    ds_read_b64_tr_b16 v[106:107], v8 offset:15360
    v_mfma_f32_32x32x16_bf16 v[28:43], v[80:83], v[116:119], v[28:43]
    s_waitcnt vmcnt(12)
    s_barrier
    ds_read_b64_tr_b16 v[76:77], v7 offset:16384
    ds_read_b64_tr_b16 v[78:79], v7 offset:17408
    s_waitcnt lgkmcnt(10)
    v_mfma_f32_32x32x16_bf16 v[44:59], v[84:87], v[116:119], v[44:59]
    s_add_u32 m0, s57, 49152
    s_nop 0
    buffer_load_dwordx4 v6, s[40:43], s63 offen lds
    ds_read_b64_tr_b16 v[80:81], v8 offset:16384
    ds_read_b64_tr_b16 v[82:83], v8 offset:17408
    v_mfma_f32_32x32x16_bf16 v[60:75], v[88:91], v[116:119], v[60:75]
    s_add_u32 m0, s57, 51200
    s_add_u32 s58, s63, 128
    buffer_load_dwordx4 v6, s[40:43], s58 offen lds
    ds_read_b64_tr_b16 v[84:85], v7 offset:18432
    ds_read_b64_tr_b16 v[86:87], v7 offset:19456
    s_waitcnt lgkmcnt(10)
    v_mfma_f32_32x32x16_bf16 v[12:27], v[92:95], v[120:123], v[12:27]
    s_add_u32 m0, s57, 50176
    s_add_u32 s58, s63, 7168
    buffer_load_dwordx4 v6, s[40:43], s58 offen lds
    ds_read_b64_tr_b16 v[88:89], v8 offset:18432
    ds_read_b64_tr_b16 v[90:91], v8 offset:19456
    v_mfma_f32_32x32x16_bf16 v[28:43], v[96:99], v[120:123], v[28:43]
    s_add_u32 m0, s57, 52224
    s_add_u32 s58, s63, 7296
    buffer_load_dwordx4 v6, s[40:43], s58 offen lds
    ds_read_b64_tr_b16 v[92:93], v7 offset:20480
    ds_read_b64_tr_b16 v[94:95], v7 offset:21504
    s_waitcnt lgkmcnt(10)
    v_mfma_f32_32x32x16_bf16 v[44:59], v[100:103], v[120:123], v[44:59]
    buffer_load_dwordx4 v[156:159], v5, s[44:47], s64 offen offset:0
    ds_read_b64_tr_b16 v[96:97], v8 offset:20480
    ds_read_b64_tr_b16 v[98:99], v8 offset:21504
    v_mfma_f32_32x32x16_bf16 v[60:75], v[104:107], v[120:123], v[60:75]
    buffer_load_dwordx4 v[160:163], v5, s[44:47], s64 offen offset:1024
    ds_read_b64_tr_b16 v[100:101], v7 offset:22528
    ds_read_b64_tr_b16 v[102:103], v7 offset:23552
    s_waitcnt lgkmcnt(10)
    s_waitcnt vmcnt(17)
    v_mfma_f32_32x32x16_bf16 v[12:27], v[76:79], v[124:127], v[12:27]
    buffer_load_dwordx4 v[164:167], v5, s[44:47], s64 offen offset:2048
    ds_read_b64_tr_b16 v[104:105], v8 offset:22528
    ds_read_b64_tr_b16 v[106:107], v8 offset:23552
    v_mfma_f32_32x32x16_bf16 v[28:43], v[80:83], v[124:127], v[28:43]
    buffer_load_dwordx4 v[168:171], v5, s[44:47], s64 offen offset:3072
    s_add_u32 s62, s62, 1
    s_add_u32 s63, s63, 57344
    s_add_u32 s64, s64, 4096
    s_cmp_eq_u32 s62, 7
    s_cselect_b32 s62, 0, s62
    s_cselect_b32 s63, s10, s63
    s_cselect_b32 s64, s11, s64
    ds_read_b64_tr_b16 v[76:77], v7 offset:24576
    ds_read_b64_tr_b16 v[78:79], v7 offset:25600
    s_waitcnt lgkmcnt(10)
    v_mfma_f32_32x32x16_bf16 v[44:59], v[84:87], v[124:127], v[44:59]
    ds_read_b64_tr_b16 v[80:81], v8 offset:24576
    ds_read_b64_tr_b16 v[82:83], v8 offset:25600
    v_mfma_f32_32x32x16_bf16 v[60:75], v[88:91], v[124:127], v[60:75]
    ds_read_b64_tr_b16 v[84:85], v7 offset:26624
    ds_read_b64_tr_b16 v[86:87], v7 offset:27648
    s_waitcnt lgkmcnt(10)
    s_waitcnt vmcnt(18)
    v_mfma_f32_32x32x16_bf16 v[12:27], v[92:95], v[128:131], v[12:27]
    ds_read_b64_tr_b16 v[88:89], v8 offset:26624
    ds_read_b64_tr_b16 v[90:91], v8 offset:27648
    v_mfma_f32_32x32x16_bf16 v[28:43], v[96:99], v[128:131], v[28:43]
    ds_read_b64_tr_b16 v[92:93], v7 offset:28672
    ds_read_b64_tr_b16 v[94:95], v7 offset:29696
    s_waitcnt lgkmcnt(10)
    v_mfma_f32_32x32x16_bf16 v[44:59], v[100:103], v[128:131], v[44:59]
    ds_read_b64_tr_b16 v[96:97], v8 offset:28672
    ds_read_b64_tr_b16 v[98:99], v8 offset:29696
    v_mfma_f32_32x32x16_bf16 v[60:75], v[104:107], v[128:131], v[60:75]
    ds_read_b64_tr_b16 v[100:101], v7 offset:30720
    ds_read_b64_tr_b16 v[102:103], v7 offset:31744
    s_waitcnt lgkmcnt(10)
    s_waitcnt vmcnt(17)
    v_mfma_f32_32x32x16_bf16 v[12:27], v[76:79], v[132:135], v[12:27]
    ds_read_b64_tr_b16 v[104:105], v8 offset:30720
    ds_read_b64_tr_b16 v[106:107], v8 offset:31744
    v_mfma_f32_32x32x16_bf16 v[28:43], v[80:83], v[132:135], v[28:43]
    s_waitcnt vmcnt(12)
    s_barrier
    ds_read_b64_tr_b16 v[76:77], v7 offset:32768
    ds_read_b64_tr_b16 v[78:79], v7 offset:33792
    s_waitcnt lgkmcnt(10)
    v_mfma_f32_32x32x16_bf16 v[44:59], v[84:87], v[132:135], v[44:59]
    s_add_u32 m0, s57, 65536
    s_nop 0
    buffer_load_dwordx4 v6, s[40:43], s63 offen lds
    ds_read_b64_tr_b16 v[80:81], v8 offset:32768
    ds_read_b64_tr_b16 v[82:83], v8 offset:33792
    v_mfma_f32_32x32x16_bf16 v[60:75], v[88:91], v[132:135], v[60:75]
    s_add_u32 m0, s57, 67584
    s_add_u32 s58, s63, 128
    buffer_load_dwordx4 v6, s[40:43], s58 offen lds
    ds_read_b64_tr_b16 v[84:85], v7 offset:34816
    ds_read_b64_tr_b16 v[86:87], v7 offset:35840
    s_waitcnt lgkmcnt(10)
    v_mfma_f32_32x32x16_bf16 v[12:27], v[92:95], v[136:139], v[12:27]
    s_add_u32 m0, s57, 66560
    s_add_u32 s58, s63, 7168
    buffer_load_dwordx4 v6, s[40:43], s58 offen lds
    ds_read_b64_tr_b16 v[88:89], v8 offset:34816
    ds_read_b64_tr_b16 v[90:91], v8 offset:35840
    v_mfma_f32_32x32x16_bf16 v[28:43], v[96:99], v[136:139], v[28:43]
    s_add_u32 m0, s57, 68608
    s_add_u32 s58, s63, 7296
    buffer_load_dwordx4 v6, s[40:43], s58 offen lds
    ds_read_b64_tr_b16 v[92:93], v7 offset:36864
    ds_read_b64_tr_b16 v[94:95], v7 offset:37888
    s_waitcnt lgkmcnt(10)
    v_mfma_f32_32x32x16_bf16 v[44:59], v[100:103], v[136:139], v[44:59]
    buffer_load_dwordx4 v[172:175], v5, s[44:47], s64 offen offset:0
    ds_read_b64_tr_b16 v[96:97], v8 offset:36864
    ds_read_b64_tr_b16 v[98:99], v8 offset:37888
    v_mfma_f32_32x32x16_bf16 v[60:75], v[104:107], v[136:139], v[60:75]
    buffer_load_dwordx4 v[176:179], v5, s[44:47], s64 offen offset:1024
    ds_read_b64_tr_b16 v[100:101], v7 offset:38912
    ds_read_b64_tr_b16 v[102:103], v7 offset:39936
    s_waitcnt lgkmcnt(10)
    s_waitcnt vmcnt(17)
    v_mfma_f32_32x32x16_bf16 v[12:27], v[76:79], v[140:143], v[12:27]
    buffer_load_dwordx4 v[180:183], v5, s[44:47], s64 offen offset:2048
    ds_read_b64_tr_b16 v[104:105], v8 offset:38912
    ds_read_b64_tr_b16 v[106:107], v8 offset:39936
    v_mfma_f32_32x32x16_bf16 v[28:43], v[80:83], v[140:143], v[28:43]
    buffer_load_dwordx4 v[184:187], v5, s[44:47], s64 offen offset:3072
    s_add_u32 s62, s62, 1
    s_add_u32 s63, s63, 57344
    s_add_u32 s64, s64, 4096
    s_cmp_eq_u32 s62, 7
    s_cselect_b32 s62, 0, s62
    s_cselect_b32 s63, s10, s63
    s_cselect_b32 s64, s11, s64
    ds_read_b64_tr_b16 v[76:77], v7 offset:40960
    ds_read_b64_tr_b16 v[78:79], v7 offset:41984
    s_waitcnt lgkmcnt(10)
    v_mfma_f32_32x32x16_bf16 v[44:59], v[84:87], v[140:143], v[44:59]
    ds_read_b64_tr_b16 v[80:81], v8 offset:40960
    ds_read_b64_tr_b16 v[82:83], v8 offset:41984
    v_mfma_f32_32x32x16_bf16 v[60:75], v[88:91], v[140:143], v[60:75]
    ds_read_b64_tr_b16 v[84:85], v7 offset:43008
    ds_read_b64_tr_b16 v[86:87], v7 offset:44032
    s_waitcnt lgkmcnt(10)
    s_waitcnt vmcnt(18)
    v_mfma_f32_32x32x16_bf16 v[12:27], v[92:95], v[144:147], v[12:27]
    ds_read_b64_tr_b16 v[88:89], v8 offset:43008
    ds_read_b64_tr_b16 v[90:91], v8 offset:44032
    v_mfma_f32_32x32x16_bf16 v[28:43], v[96:99], v[144:147], v[28:43]
    ds_read_b64_tr_b16 v[92:93], v7 offset:45056
    ds_read_b64_tr_b16 v[94:95], v7 offset:46080
    s_waitcnt lgkmcnt(10)
    v_mfma_f32_32x32x16_bf16 v[44:59], v[100:103], v[144:147], v[44:59]
    ds_read_b64_tr_b16 v[96:97], v8 offset:45056
    ds_read_b64_tr_b16 v[98:99], v8 offset:46080
    v_mfma_f32_32x32x16_bf16 v[60:75], v[104:107], v[144:147], v[60:75]
    ds_read_b64_tr_b16 v[100:101], v7 offset:47104
    ds_read_b64_tr_b16 v[102:103], v7 offset:48128
    s_waitcnt lgkmcnt(10)
    s_waitcnt vmcnt(17)
    v_mfma_f32_32x32x16_bf16 v[12:27], v[76:79], v[148:151], v[12:27]
    ds_read_b64_tr_b16 v[104:105], v8 offset:47104
    ds_read_b64_tr_b16 v[106:107], v8 offset:48128
    v_mfma_f32_32x32x16_bf16 v[28:43], v[80:83], v[148:151], v[28:43]
    s_waitcnt vmcnt(12)
    s_barrier
    ds_read_b64_tr_b16 v[76:77], v7 offset:49152
    ds_read_b64_tr_b16 v[78:79], v7 offset:50176
    s_waitcnt lgkmcnt(10)
    v_mfma_f32_32x32x16_bf16 v[44:59], v[84:87], v[148:151], v[44:59]
    s_add_u32 m0, s57, 81920
    s_nop 0
    buffer_load_dwordx4 v6, s[40:43], s63 offen lds
    ds_read_b64_tr_b16 v[80:81], v8 offset:49152
    ds_read_b64_tr_b16 v[82:83], v8 offset:50176
    v_mfma_f32_32x32x16_bf16 v[60:75], v[88:91], v[148:151], v[60:75]
    s_add_u32 m0, s57, 83968
    s_add_u32 s58, s63, 128
    buffer_load_dwordx4 v6, s[40:43], s58 offen lds
    ds_read_b64_tr_b16 v[84:85], v7 offset:51200
    ds_read_b64_tr_b16 v[86:87], v7 offset:52224
    s_waitcnt lgkmcnt(10)
    v_mfma_f32_32x32x16_bf16 v[12:27], v[92:95], v[152:155], v[12:27]
    s_add_u32 m0, s57, 82944
    s_add_u32 s58, s63, 7168
    buffer_load_dwordx4 v6, s[40:43], s58 offen lds
    ds_read_b64_tr_b16 v[88:89], v8 offset:51200
    ds_read_b64_tr_b16 v[90:91], v8 offset:52224
    v_mfma_f32_32x32x16_bf16 v[28:43], v[96:99], v[152:155], v[28:43]
    s_add_u32 m0, s57, 84992
    s_add_u32 s58, s63, 7296
    buffer_load_dwordx4 v6, s[40:43], s58 offen lds
    ds_read_b64_tr_b16 v[92:93], v7 offset:53248
    ds_read_b64_tr_b16 v[94:95], v7 offset:54272
    s_waitcnt lgkmcnt(10)
    v_mfma_f32_32x32x16_bf16 v[44:59], v[100:103], v[152:155], v[44:59]
    buffer_load_dwordx4 v[188:191], v5, s[44:47], s64 offen offset:0
    ds_read_b64_tr_b16 v[96:97], v8 offset:53248
    ds_read_b64_tr_b16 v[98:99], v8 offset:54272
    v_mfma_f32_32x32x16_bf16 v[60:75], v[104:107], v[152:155], v[60:75]
    buffer_load_dwordx4 v[192:195], v5, s[44:47], s64 offen offset:1024
    ds_read_b64_tr_b16 v[100:101], v7 offset:55296
    ds_read_b64_tr_b16 v[102:103], v7 offset:56320
    s_waitcnt lgkmcnt(10)
    s_waitcnt vmcnt(17)
    v_mfma_f32_32x32x16_bf16 v[12:27], v[76:79], v[156:159], v[12:27]
    buffer_load_dwordx4 v[196:199], v5, s[44:47], s64 offen offset:2048
    ds_read_b64_tr_b16 v[104:105], v8 offset:55296
    ds_read_b64_tr_b16 v[106:107], v8 offset:56320
    v_mfma_f32_32x32x16_bf16 v[28:43], v[80:83], v[156:159], v[28:43]
    buffer_load_dwordx4 v[200:203], v5, s[44:47], s64 offen offset:3072
    s_add_u32 s62, s62, 1
    s_add_u32 s63, s63, 57344
    s_add_u32 s64, s64, 4096
    s_cmp_eq_u32 s62, 7
    s_cselect_b32 s62, 0, s62
    s_cselect_b32 s63, s10, s63
    s_cselect_b32 s64, s11, s64
    ds_read_b64_tr_b16 v[76:77], v7 offset:57344
    ds_read_b64_tr_b16 v[78:79], v7 offset:58368
    s_waitcnt lgkmcnt(10)
    v_mfma_f32_32x32x16_bf16 v[44:59], v[84:87], v[156:159], v[44:59]
    ds_read_b64_tr_b16 v[80:81], v8 offset:57344
    ds_read_b64_tr_b16 v[82:83], v8 offset:58368
    v_mfma_f32_32x32x16_bf16 v[60:75], v[88:91], v[156:159], v[60:75]
    ds_read_b64_tr_b16 v[84:85], v7 offset:59392
    ds_read_b64_tr_b16 v[86:87], v7 offset:60416
    s_waitcnt lgkmcnt(10)
    s_waitcnt vmcnt(18)
    v_mfma_f32_32x32x16_bf16 v[12:27], v[92:95], v[160:163], v[12:27]
    ds_read_b64_tr_b16 v[88:89], v8 offset:59392
    ds_read_b64_tr_b16 v[90:91], v8 offset:60416
    v_mfma_f32_32x32x16_bf16 v[28:43], v[96:99], v[160:163], v[28:43]
    ds_read_b64_tr_b16 v[92:93], v7 offset:61440
    ds_read_b64_tr_b16 v[94:95], v7 offset:62464
    s_waitcnt lgkmcnt(10)
    v_mfma_f32_32x32x16_bf16 v[44:59], v[100:103], v[160:163], v[44:59]
    ds_read_b64_tr_b16 v[96:97], v8 offset:61440
    ds_read_b64_tr_b16 v[98:99], v8 offset:62464
    v_mfma_f32_32x32x16_bf16 v[60:75], v[104:107], v[160:163], v[60:75]
    ds_read_b64_tr_b16 v[100:101], v7 offset:63488
    ds_read_b64_tr_b16 v[102:103], v7 offset:64512
    s_waitcnt lgkmcnt(10)
    s_waitcnt vmcnt(17)
    v_mfma_f32_32x32x16_bf16 v[12:27], v[76:79], v[164:167], v[12:27]
    ds_read_b64_tr_b16 v[104:105], v8 offset:63488
    ds_read_b64_tr_b16 v[106:107], v8 offset:64512
    v_mfma_f32_32x32x16_bf16 v[28:43], v[80:83], v[164:167], v[28:43]
    s_waitcnt vmcnt(12)
    s_barrier
    ds_read_b64_tr_b16 v[76:77], v9 offset:0
    ds_read_b64_tr_b16 v[78:79], v9 offset:1024
    s_waitcnt lgkmcnt(10)
    v_mfma_f32_32x32x16_bf16 v[44:59], v[84:87], v[164:167], v[44:59]
    s_add_u32 m0, s57, 98304
    s_nop 0
    buffer_load_dwordx4 v6, s[40:43], s63 offen lds
    ds_read_b64_tr_b16 v[80:81], v10 offset:0
    ds_read_b64_tr_b16 v[82:83], v10 offset:1024
    v_mfma_f32_32x32x16_bf16 v[60:75], v[88:91], v[164:167], v[60:75]
    s_add_u32 m0, s57, 100352
    s_add_u32 s58, s63, 128
    buffer_load_dwordx4 v6, s[40:43], s58 offen lds
    ds_read_b64_tr_b16 v[84:85], v9 offset:2048
    ds_read_b64_tr_b16 v[86:87], v9 offset:3072
    s_waitcnt lgkmcnt(10)
    v_mfma_f32_32x32x16_bf16 v[12:27], v[92:95], v[168:171], v[12:27]
    s_add_u32 m0, s57, 99328
    s_add_u32 s58, s63, 7168
    buffer_load_dwordx4 v6, s[40:43], s58 offen lds
    ds_read_b64_tr_b16 v[88:89], v10 offset:2048
    ds_read_b64_tr_b16 v[90:91], v10 offset:3072
    v_mfma_f32_32x32x16_bf16 v[28:43], v[96:99], v[168:171], v[28:43]
    s_add_u32 m0, s57, 101376
    s_add_u32 s58, s63, 7296
    buffer_load_dwordx4 v6, s[40:43], s58 offen lds
    ds_read_b64_tr_b16 v[92:93], v9 offset:4096
    ds_read_b64_tr_b16 v[94:95], v9 offset:5120
    s_waitcnt lgkmcnt(10)
    v_mfma_f32_32x32x16_bf16 v[44:59], v[100:103], v[168:171], v[44:59]
    buffer_load_dwordx4 v[204:207], v5, s[44:47], s64 offen offset:0
    ds_read_b64_tr_b16 v[96:97], v10 offset:4096
    ds_read_b64_tr_b16 v[98:99], v10 offset:5120
    v_mfma_f32_32x32x16_bf16 v[60:75], v[104:107], v[168:171], v[60:75]
    buffer_load_dwordx4 v[208:211], v5, s[44:47], s64 offen offset:1024
    ds_read_b64_tr_b16 v[100:101], v9 offset:6144
    ds_read_b64_tr_b16 v[102:103], v9 offset:7168
    s_waitcnt lgkmcnt(10)
    s_waitcnt vmcnt(17)
    v_mfma_f32_32x32x16_bf16 v[12:27], v[76:79], v[172:175], v[12:27]
    buffer_load_dwordx4 v[212:215], v5, s[44:47], s64 offen offset:2048
    ds_read_b64_tr_b16 v[104:105], v10 offset:6144
    ds_read_b64_tr_b16 v[106:107], v10 offset:7168
    v_mfma_f32_32x32x16_bf16 v[28:43], v[80:83], v[172:175], v[28:43]
    buffer_load_dwordx4 v[216:219], v5, s[44:47], s64 offen offset:3072
    s_add_u32 s62, s62, 1
    s_add_u32 s63, s63, 57344
    s_add_u32 s64, s64, 4096
    s_cmp_eq_u32 s62, 7
    s_cselect_b32 s62, 0, s62
    s_cselect_b32 s63, s10, s63
    s_cselect_b32 s64, s11, s64
    ds_read_b64_tr_b16 v[76:77], v9 offset:8192
    ds_read_b64_tr_b16 v[78:79], v9 offset:9216
    s_waitcnt lgkmcnt(10)
    v_mfma_f32_32x32x16_bf16 v[44:59], v[84:87], v[172:175], v[44:59]
    ds_read_b64_tr_b16 v[80:81], v10 offset:8192
    ds_read_b64_tr_b16 v[82:83], v10 offset:9216
    v_mfma_f32_32x32x16_bf16 v[60:75], v[88:91], v[172:175], v[60:75]
    ds_read_b64_tr_b16 v[84:85], v9 offset:10240
    ds_read_b64_tr_b16 v[86:87], v9 offset:11264
    s_waitcnt lgkmcnt(10)
    s_waitcnt vmcnt(18)
    v_mfma_f32_32x32x16_bf16 v[12:27], v[92:95], v[176:179], v[12:27]
    ds_read_b64_tr_b16 v[88:89], v10 offset:10240
    ds_read_b64_tr_b16 v[90:91], v10 offset:11264
    v_mfma_f32_32x32x16_bf16 v[28:43], v[96:99], v[176:179], v[28:43]
    ds_read_b64_tr_b16 v[92:93], v9 offset:12288
    ds_read_b64_tr_b16 v[94:95], v9 offset:13312
    s_waitcnt lgkmcnt(10)
    v_mfma_f32_32x32x16_bf16 v[44:59], v[100:103], v[176:179], v[44:59]
    ds_read_b64_tr_b16 v[96:97], v10 offset:12288
    ds_read_b64_tr_b16 v[98:99], v10 offset:13312
    v_mfma_f32_32x32x16_bf16 v[60:75], v[104:107], v[176:179], v[60:75]
    ds_read_b64_tr_b16 v[100:101], v9 offset:14336
    ds_read_b64_tr_b16 v[102:103], v9 offset:15360
    s_waitcnt lgkmcnt(10)
    s_waitcnt vmcnt(17)
    v_mfma_f32_32x32x16_bf16 v[12:27], v[76:79], v[180:183], v[12:27]
    ds_read_b64_tr_b16 v[104:105], v10 offset:14336
    ds_read_b64_tr_b16 v[106:107], v10 offset:15360
    v_mfma_f32_32x32x16_bf16 v[28:43], v[80:83], v[180:183], v[28:43]
    s_waitcnt vmcnt(12)
    s_barrier
    ds_read_b64_tr_b16 v[76:77], v9 offset:16384
    ds_read_b64_tr_b16 v[78:79], v9 offset:17408
    s_waitcnt lgkmcnt(10)
    v_mfma_f32_32x32x16_bf16 v[44:59], v[84:87], v[180:183], v[44:59]
    ds_read_b64_tr_b16 v[80:81], v10 offset:16384
    ds_read_b64_tr_b16 v[82:83], v10 offset:17408
    v_mfma_f32_32x32x16_bf16 v[60:75], v[88:91], v[180:183], v[60:75]
    ds_read_b64_tr_b16 v[84:85], v9 offset:18432
    ds_read_b64_tr_b16 v[86:87], v9 offset:19456
    s_waitcnt lgkmcnt(10)
    v_mfma_f32_32x32x16_bf16 v[12:27], v[92:95], v[184:187], v[12:27]
    ds_read_b64_tr_b16 v[88:89], v10 offset:18432
    ds_read_b64_tr_b16 v[90:91], v10 offset:19456
    v_mfma_f32_32x32x16_bf16 v[28:43], v[96:99], v[184:187], v[28:43]
    ds_read_b64_tr_b16 v[92:93], v9 offset:20480
    ds_read_b64_tr_b16 v[94:95], v9 offset:21504
    s_waitcnt lgkmcnt(10)
    v_mfma_f32_32x32x16_bf16 v[44:59], v[100:103], v[184:187], v[44:59]
    ds_read_b64_tr_b16 v[96:97], v10 offset:20480
    ds_read_b64_tr_b16 v[98:99], v10 offset:21504
    v_mfma_f32_32x32x16_bf16 v[60:75], v[104:107], v[184:187], v[60:75]
    ds_read_b64_tr_b16 v[100:101], v9 offset:22528
    ds_read_b64_tr_b16 v[102:103], v9 offset:23552
    s_waitcnt lgkmcnt(10)
    s_waitcnt vmcnt(11)
    v_mfma_f32_32x32x16_bf16 v[12:27], v[76:79], v[188:191], v[12:27]
    ds_read_b64_tr_b16 v[104:105], v10 offset:22528
    ds_read_b64_tr_b16 v[106:107], v10 offset:23552
    v_mfma_f32_32x32x16_bf16 v[28:43], v[80:83], v[188:191], v[28:43]
    ds_read_b64_tr_b16 v[76:77], v9 offset:24576
    ds_read_b64_tr_b16 v[78:79], v9 offset:25600
    s_waitcnt lgkmcnt(10)
    v_mfma_f32_32x32x16_bf16 v[44:59], v[84:87], v[188:191], v[44:59]
    ds_read_b64_tr_b16 v[80:81], v10 offset:24576
    ds_read_b64_tr_b16 v[82:83], v10 offset:25600
    v_mfma_f32_32x32x16_bf16 v[60:75], v[88:91], v[188:191], v[60:75]
    ds_read_b64_tr_b16 v[84:85], v9 offset:26624
    ds_read_b64_tr_b16 v[86:87], v9 offset:27648
    s_waitcnt lgkmcnt(10)
    s_waitcnt vmcnt(10)
    v_mfma_f32_32x32x16_bf16 v[12:27], v[92:95], v[192:195], v[12:27]
    ds_read_b64_tr_b16 v[88:89], v10 offset:26624
    ds_read_b64_tr_b16 v[90:91], v10 offset:27648
    v_mfma_f32_32x32x16_bf16 v[28:43], v[96:99], v[192:195], v[28:43]
    ds_read_b64_tr_b16 v[92:93], v9 offset:28672
    ds_read_b64_tr_b16 v[94:95], v9 offset:29696
    s_waitcnt lgkmcnt(10)
    v_mfma_f32_32x32x16_bf16 v[44:59], v[100:103], v[192:195], v[44:59]
    ds_read_b64_tr_b16 v[96:97], v10 offset:28672
    ds_read_b64_tr_b16 v[98:99], v10 offset:29696
    v_mfma_f32_32x32x16_bf16 v[60:75], v[104:107], v[192:195], v[60:75]
    ds_read_b64_tr_b16 v[100:101], v9 offset:30720
    ds_read_b64_tr_b16 v[102:103], v9 offset:31744
    s_waitcnt lgkmcnt(10)
    s_waitcnt vmcnt(9)
    v_mfma_f32_32x32x16_bf16 v[12:27], v[76:79], v[196:199], v[12:27]
    ds_read_b64_tr_b16 v[104:105], v10 offset:30720
    ds_read_b64_tr_b16 v[106:107], v10 offset:31744
    v_mfma_f32_32x32x16_bf16 v[28:43], v[80:83], v[196:199], v[28:43]
    s_waitcnt vmcnt(4)
    s_barrier
    ds_read_b64_tr_b16 v[76:77], v9 offset:32768
    ds_read_b64_tr_b16 v[78:79], v9 offset:33792
    s_waitcnt lgkmcnt(10)
    v_mfma_f32_32x32x16_bf16 v[44:59], v[84:87], v[196:199], v[44:59]
    ds_read_b64_tr_b16 v[80:81], v10 offset:32768
    ds_read_b64_tr_b16 v[82:83], v10 offset:33792
    v_mfma_f32_32x32x16_bf16 v[60:75], v[88:91], v[196:199], v[60:75]
    ds_read_b64_tr_b16 v[84:85], v9 offset:34816
    ds_read_b64_tr_b16 v[86:87], v9 offset:35840
    s_waitcnt lgkmcnt(10)
    v_mfma_f32_32x32x16_bf16 v[12:27], v[92:95], v[200:203], v[12:27]
    ds_read_b64_tr_b16 v[88:89], v10 offset:34816
    ds_read_b64_tr_b16 v[90:91], v10 offset:35840
    v_mfma_f32_32x32x16_bf16 v[28:43], v[96:99], v[200:203], v[28:43]
    ds_read_b64_tr_b16 v[92:93], v9 offset:36864
    ds_read_b64_tr_b16 v[94:95], v9 offset:37888
    s_waitcnt lgkmcnt(10)
    v_mfma_f32_32x32x16_bf16 v[44:59], v[100:103], v[200:203], v[44:59]
    ds_read_b64_tr_b16 v[96:97], v10 offset:36864
    ds_read_b64_tr_b16 v[98:99], v10 offset:37888
    v_mfma_f32_32x32x16_bf16 v[60:75], v[104:107], v[200:203], v[60:75]
    ds_read_b64_tr_b16 v[100:101], v9 offset:38912
    ds_read_b64_tr_b16 v[102:103], v9 offset:39936
    s_waitcnt lgkmcnt(10)
    s_waitcnt vmcnt(3)
    v_mfma_f32_32x32x16_bf16 v[12:27], v[76:79], v[204:207], v[12:27]
    ds_read_b64_tr_b16 v[104:105], v10 offset:38912
    ds_read_b64_tr_b16 v[106:107], v10 offset:39936
    v_mfma_f32_32x32x16_bf16 v[28:43], v[80:83], v[204:207], v[28:43]
    ds_read_b64_tr_b16 v[76:77], v9 offset:40960
    ds_read_b64_tr_b16 v[78:79], v9 offset:41984
    s_waitcnt lgkmcnt(10)
    v_mfma_f32_32x32x16_bf16 v[44:59], v[84:87], v[204:207], v[44:59]
    ds_read_b64_tr_b16 v[80:81], v10 offset:40960
    ds_read_b64_tr_b16 v[82:83], v10 offset:41984
    v_mfma_f32_32x32x16_bf16 v[60:75], v[88:91], v[204:207], v[60:75]
    ds_read_b64_tr_b16 v[84:85], v9 offset:43008
    ds_read_b64_tr_b16 v[86:87], v9 offset:44032
    s_waitcnt lgkmcnt(10)
    s_waitcnt vmcnt(2)
    v_mfma_f32_32x32x16_bf16 v[12:27], v[92:95], v[208:211], v[12:27]
    ds_read_b64_tr_b16 v[88:89], v10 offset:43008
    ds_read_b64_tr_b16 v[90:91], v10 offset:44032
    v_mfma_f32_32x32x16_bf16 v[28:43], v[96:99], v[208:211], v[28:43]
    ds_read_b64_tr_b16 v[92:93], v9 offset:45056
    ds_read_b64_tr_b16 v[94:95], v9 offset:46080
    s_waitcnt lgkmcnt(10)
    v_mfma_f32_32x32x16_bf16 v[44:59], v[100:103], v[208:211], v[44:59]
    ds_read_b64_tr_b16 v[96:97], v10 offset:45056
    ds_read_b64_tr_b16 v[98:99], v10 offset:46080
    v_mfma_f32_32x32x16_bf16 v[60:75], v[104:107], v[208:211], v[60:75]
    ds_read_b64_tr_b16 v[100:101], v9 offset:47104
    ds_read_b64_tr_b16 v[102:103], v9 offset:48128
    s_waitcnt lgkmcnt(10)
    s_waitcnt vmcnt(1)
    v_mfma_f32_32x32x16_bf16 v[12:27], v[76:79], v[212:215], v[12:27]
    ds_read_b64_tr_b16 v[104:105], v10 offset:47104
    ds_read_b64_tr_b16 v[106:107], v10 offset:48128
    v_mfma_f32_32x32x16_bf16 v[28:43], v[80:83], v[212:215], v[28:43]
    s_waitcnt lgkmcnt(8)
    v_mfma_f32_32x32x16_bf16 v[44:59], v[84:87], v[212:215], v[44:59]
    v_mfma_f32_32x32x16_bf16 v[60:75], v[88:91], v[212:215], v[60:75]
    s_waitcnt lgkmcnt(4)
    s_waitcnt vmcnt(0)
    v_mfma_f32_32x32x16_bf16 v[12:27], v[92:95], v[216:219], v[12:27]
    v_mfma_f32_32x32x16_bf16 v[28:43], v[96:99], v[216:219], v[28:43]
    s_waitcnt lgkmcnt(0)
    v_mfma_f32_32x32x16_bf16 v[44:59], v[100:103], v[216:219], v[44:59]
    v_mfma_f32_32x32x16_bf16 v[60:75], v[104:107], v[216:219], v[60:75]
    s_cmp_eq_u32 s7, 3
    s_cbranch_scc1 g4_skip
    s_nop 5
    v_cvt_pk_bf16_f32 v108, v12, v13
    v_cvt_pk_bf16_f32 v109, v14, v15
    v_cvt_pk_bf16_f32 v110, v16, v17
    v_cvt_pk_bf16_f32 v111, v18, v19
    buffer_store_dwordx4 v[108:111], v5, s[44:47], s60 offen offset:0 sc0 sc1
    v_cvt_pk_bf16_f32 v112, v20, v21
    v_cvt_pk_bf16_f32 v113, v22, v23
    v_cvt_pk_bf16_f32 v114, v24, v25
    v_cvt_pk_bf16_f32 v115, v26, v27
    buffer_store_dwordx4 v[112:115], v5, s[44:47], s60 offen offset:1024 sc0 sc1
    v_cvt_pk_bf16_f32 v116, v28, v29
    v_cvt_pk_bf16_f32 v117, v30, v31
    v_cvt_pk_bf16_f32 v118, v32, v33
    v_cvt_pk_bf16_f32 v119, v34, v35
    buffer_store_dwordx4 v[116:119], v5, s[44:47], s60 offen offset:2048 sc0 sc1
    v_cvt_pk_bf16_f32 v120, v36, v37
    v_cvt_pk_bf16_f32 v121, v38, v39
    v_cvt_pk_bf16_f32 v122, v40, v41
    v_cvt_pk_bf16_f32 v123, v42, v43
    buffer_store_dwordx4 v[120:123], v5, s[44:47], s60 offen offset:3072 sc0 sc1
g4_skip:
    s_nop 7
    s_nop 7
    v_cvt_pk_bf16_f32 v124, v44, v45
    v_cvt_pk_bf16_f32 v125, v46, v47
    v_cvt_pk_bf16_f32 v126, v48, v49
    v_cvt_pk_bf16_f32 v127, v50, v51
    buffer_store_dwordx4 v[124:127], v5, s[44:47], s61 offen offset:0 sc0 sc1
    v_cvt_pk_bf16_f32 v128, v52, v53
    v_cvt_pk_bf16_f32 v129, v54, v55
    v_cvt_pk_bf16_f32 v130, v56, v57
    v_cvt_pk_bf16_f32 v131, v58, v59
    buffer_store_dwordx4 v[128:131], v5, s[44:47], s61 offen offset:1024 sc0 sc1
    v_cvt_pk_bf16_f32 v132, v60, v61
    v_cvt_pk_bf16_f32 v133, v62, v63
    v_cvt_pk_bf16_f32 v134, v64, v65
    v_cvt_pk_bf16_f32 v135, v66, v67
    buffer_store_dwordx4 v[132:135], v5, s[44:47], s61 offen offset:2048 sc0 sc1
    v_cvt_pk_bf16_f32 v136, v68, v69
    v_cvt_pk_bf16_f32 v137, v70, v71
    v_cvt_pk_bf16_f32 v138, v72, v73
    v_cvt_pk_bf16_f32 v139, v74, v75
    buffer_store_dwordx4 v[136:139], v5, s[44:47], s61 offen offset:3072 sc0 sc1
    s_endpgm
k2_fft:
    s_cmp_ge_u32 s2, 225
    s_cbranch_scc1 k2_kernel_end
    s_sub_u32 s3, s3, 4
    s_setprio 3
    v_and_b32 v2, 15, v1
    v_lshrrev_b32 v3, 4, v1
    v_lshlrev_b32 v4, 4, v1
    v_lshlrev_b32 v5, 4, v2
    v_lshl_add_u32 v5, v3, 9, v5
    s_lshl_b32 s4, s2, 13
    s_add_u32 s5, s4, 4096
    s_cmp_eq_u32 s2, 224
    s_cselect_b32 s4, 4096, s4
    s_cselect_b32 s5, 268435456, s5
    s_cmp_eq_u32 s2, 0
    s_cselect_b32 s5, 268435456, s5
    s_add_u32 s6, s4, 14680064
    s_add_u32 s7, s5, 14680064
    s_add_u32 s8, s4, 14680064
    s_add_u32 s9, s5, 14680064
    s_lshl_b32 s11, s2, 13
    s_lshl_b32 s12, s3, 11
    s_add_u32 s11, s11, s12
    s_add_u32 s11, s11, 16515072
    s_cmp_lt_u32 s3, 2
    s_cselect_b32 s10, s6, s7
    s_and_b32 s13, s12, 2048
    s_add_u32 s10, s10, s13
    s_add_u32 m0, s12, 122880
    v_lshlrev_b32 v188, 31, v1
    v_lshrrev_b32 v6, 16, v188
    v_or_b32 v188, v188, v6
    s_mov_b32 s15, 0x80008000
    s_brev_b32 s12, 1
    s_lshl_b32 s13, s3, 4
    v_add_u32 v6, s13, v2
    v_cvt_f32_u32 v6, v6
    v_mul_f32 v6, 0x3a000000, v6
    v_lshlrev_b32 v7, 2, v3
    v_add_u32 v9, s13, v7
    v_cvt_f32_u32 v7, v7
    v_mul_f32 v7, v7, v6
    v_fmamk_f32 v116, v6, 0x00000000, v7
    v_fmamk_f32 v117, v6, 0x3f800000, v7
    v_fmamk_f32 v118, v6, 0x40000000, v7
    v_fmamk_f32 v119, v6, 0x40400000, v7
    v_fmamk_f32 v120, v6, 0x41800000, v7
    v_fmamk_f32 v121, v6, 0x41880000, v7
    v_fmamk_f32 v122, v6, 0x41900000, v7
    v_fmamk_f32 v123, v6, 0x41980000, v7
    v_sin_f32 v124, v116
    v_cos_f32 v116, v116
    v_sin_f32 v125, v117
    v_cos_f32 v117, v117
    v_sin_f32 v126, v118
    v_cos_f32 v118, v118
    v_sin_f32 v127, v119
    v_cos_f32 v119, v119
    v_sin_f32 v128, v120
    v_cos_f32 v120, v120
    v_sin_f32 v129, v121
    v_cos_f32 v121, v121
    v_sin_f32 v130, v122
    v_cos_f32 v122, v122
    v_sin_f32 v131, v123
    v_cos_f32 v123, v123
    s_waitcnt lgkmcnt(0)
    s_mov_b32 s44, s34
    s_and_b32 s45, s35, 0xffff
    s_mov_b32 s46, 268435456
    s_mov_b32 s47, 0x00020000
    buffer_load_dwordx4 v4, s[44:47], s10 offen offset:0 lds
    buffer_load_dwordx4 v4, s[44:47], s10 offen offset:1024 lds
    buffer_load_dwordx4 v[92:95], v4, s[44:47], s11 offen offset:0
    buffer_load_dwordx4 v[96:99], v4, s[44:47], s11 offen offset:1024
    v_cvt_f32_u32 v6, v2
    v_mul_f32 v6, 0x3a000000, v6
    v_add_f32 v8, 0x3c000000, v6
    v_cvt_f32_u32 v7, v9
    v_add_f32 v132, 0x00000000, v7
    v_mul_f32 v132, v132, v6
    v_add_f32 v133, 0x3f800000, v7
    v_mul_f32 v133, v133, v6
    v_add_f32 v134, 0x40000000, v7
    v_mul_f32 v134, v134, v6
    v_add_f32 v135, 0x40400000, v7
    v_mul_f32 v135, v135, v6
    v_add_f32 v136, 0x00000000, v7
    v_mul_f32 v136, v136, v8
    v_add_f32 v137, 0x3f800000, v7
    v_mul_f32 v137, v137, v8
    v_add_f32 v138, 0x40000000, v7
    v_mul_f32 v138, v138, v8
    v_add_f32 v139, 0x40400000, v7
    v_mul_f32 v139, v139, v8
    v_sin_f32 v140, v132
    v_cos_f32 v132, v132
    v_sin_f32 v141, v133
    v_cos_f32 v133, v133
    v_sin_f32 v142, v134
    v_cos_f32 v134, v134
    v_sin_f32 v143, v135
    v_cos_f32 v135, v135
    v_sin_f32 v144, v136
    v_cos_f32 v136, v136
    v_sin_f32 v145, v137
    v_cos_f32 v137, v137
    v_sin_f32 v146, v138
    v_cos_f32 v138, v138
    v_sin_f32 v147, v139
    v_cos_f32 v139, v139
    v_mul_f32 v6, 0x42800000, v6
    v_lshlrev_b32 v7, 2, v3
    v_cvt_f32_u32 v7, v7
    v_mul_f32 v164, v7, v6
    v_fmamk_f32 v165, v6, 0x3f800000, v164
    v_fmamk_f32 v166, v6, 0x40000000, v164
    v_fmamk_f32 v167, v6, 0x40400000, v164
    v_sin_f32 v172, v164
    v_cos_f32 v164, v164
    v_sin_f32 v173, v165
    v_cos_f32 v165, v165
    v_sin_f32 v174, v166
    v_cos_f32 v166, v166
    v_sin_f32 v175, v167
    v_cos_f32 v167, v167
    v_cvt_pk_bf16_f32 v68, v164, v165
    v_cvt_pk_bf16_f32 v69, v166, v167
    v_xor_b32 v70, v68, v188
    v_xor_b32 v71, v69, v188
    v_xor_b32 v80, s12, v68
    v_xor_b32 v81, s12, v69
    v_xor_b32 v82, s12, v70
    v_xor_b32 v83, s12, v71
    v_cvt_pk_bf16_f32 v72, v172, v173
    v_cvt_pk_bf16_f32 v73, v174, v175
    v_xor_b32 v74, v72, v188
    v_xor_b32 v75, v73, v188
    v_xor_b32 v84, s12, v72
    v_xor_b32 v85, s12, v73
    v_xor_b32 v86, s12, v74
    v_xor_b32 v87, s12, v75
    v_xor_b32 v76, s15, v72
    v_xor_b32 v77, s15, v73
    v_xor_b32 v78, s15, v74
    v_xor_b32 v79, s15, v75
    v_xor_b32 v88, s15, v84
    v_xor_b32 v89, s15, v85
    v_xor_b32 v90, s15, v86
    v_xor_b32 v91, s15, v87
    v_add_u32 v6, s13, v2
    v_cvt_f32_u32 v6, v6
    v_mul_f32 v6, 0x3c800000, v6
    v_lshrrev_b32 v7, 1, v3
    v_lshlrev_b32 v7, 3, v7
    v_lshl_add_u32 v7, v3, 2, v7
    v_cvt_f32_u32 v7, v7
    v_mul_f32 v164, v7, v6
    v_fmamk_f32 v165, v6, 0x3f800000, v164
    v_fmamk_f32 v166, v6, 0x40000000, v164
    v_fmamk_f32 v167, v6, 0x40400000, v164
    v_fmamk_f32 v168, v6, 0x41000000, v164
    v_fmamk_f32 v169, v6, 0x41100000, v164
    v_fmamk_f32 v170, v6, 0x41200000, v164
    v_fmamk_f32 v171, v6, 0x41300000, v164
    v_sin_f32 v172, v164
    v_cos_f32 v164, v164
    v_sin_f32 v173, v165
    v_cos_f32 v165, v165
    v_sin_f32 v174, v166
    v_cos_f32 v166, v166
    v_sin_f32 v175, v167
    v_cos_f32 v167, v167
    v_sin_f32 v176, v168
    v_cos_f32 v168, v168
    v_sin_f32 v177, v169
    v_cos_f32 v169, v169
    v_sin_f32 v178, v170
    v_cos_f32 v170, v170
    v_sin_f32 v179, v171
    v_cos_f32 v171, v171
    v_cvt_pk_bf16_f32 v44, v164, v165
    v_cvt_pk_bf16_f32 v45, v166, v167
    v_cvt_pk_bf16_f32 v46, v168, v169
    v_cvt_pk_bf16_f32 v47, v170, v171
    v_xor_b32 v56, v44, v188
    v_xor_b32 v57, v45, v188
    v_xor_b32 v58, v46, v188
    v_xor_b32 v59, v47, v188
    v_cvt_pk_bf16_f32 v48, v172, v173
    v_cvt_pk_bf16_f32 v49, v174, v175
    v_cvt_pk_bf16_f32 v50, v176, v177
    v_cvt_pk_bf16_f32 v51, v178, v179
    v_xor_b32 v60, v48, v188
    v_xor_b32 v61, v49, v188
    v_xor_b32 v62, v50, v188
    v_xor_b32 v63, v51, v188
    v_xor_b32 v52, s15, v48
    v_xor_b32 v53, s15, v49
    v_xor_b32 v54, s15, v50
    v_xor_b32 v55, s15, v51
    v_xor_b32 v64, s15, v60
    v_xor_b32 v65, s15, v61
    v_xor_b32 v66, s15, v62
    v_xor_b32 v67, s15, v63
    v_add_u32 v8, 122880, v5
    v_lshlrev_b32 v9, 1, v9
    v_lshl_add_u32 v9, v2, 7, v9
    v_and_b32 v6, 1, v3
    v_lshlrev_b32 v6, 8, v6
    v_lshl_add_u32 v6, v2, 4, v6
    v_lshrrev_b32 v7, 1, v3
    v_lshl_add_u32 v6, v7, 3, v6
    s_lshl_b32 s14, s3, 9
    s_add_u32 s14, s14, 114688
    v_add_u32 v10, s14, v6
    v_add_u32 v5, 114688, v4
    s_waitcnt vmcnt(2)
    s_barrier
    ds_read_b128 v[12:15], v8 offset:0
    ds_read_b128 v[20:23], v8 offset:256
    ds_read_b128 v[28:31], v8 offset:4096
    ds_read_b128 v[36:39], v8 offset:4352
    ds_read_b128 v[16:19], v8 offset:2048
    ds_read_b128 v[24:27], v8 offset:2304
    ds_read_b128 v[32:35], v8 offset:6144
    ds_read_b128 v[40:43], v8 offset:6400
    s_cmp_lt_u32 s5, 268435456
    s_cbranch_scc1 fft_nz
    s_waitcnt lgkmcnt(0)
    v_mov_b32 v28, 0
    v_mov_b32 v29, 0
    v_mov_b32 v30, 0
    v_mov_b32 v31, 0
    v_mov_b32 v32, 0
    v_mov_b32 v33, 0
    v_mov_b32 v34, 0
    v_mov_b32 v35, 0
    v_mov_b32 v36, 0
    v_mov_b32 v37, 0
    v_mov_b32 v38, 0
    v_mov_b32 v39, 0
    v_mov_b32 v40, 0
    v_mov_b32 v41, 0
    v_mov_b32 v42, 0
    v_mov_b32 v43, 0
fft_nz:
    s_waitcnt lgkmcnt(7)
    v_mfma_f32_16x16x32_bf16 v[148:151], v[12:15], v[44:47], 0
    v_mfma_f32_16x16x32_bf16 v[156:159], v[12:15], v[52:55], 0
    s_waitcnt lgkmcnt(6)
    v_mfma_f32_16x16x32_bf16 v[152:155], v[20:23], v[44:47], 0
    v_mfma_f32_16x16x32_bf16 v[160:163], v[20:23], v[52:55], 0
    s_waitcnt lgkmcnt(5)
    v_mfma_f32_16x16x32_bf16 v[148:151], v[28:31], v[48:51], v[148:151]
    v_mfma_f32_16x16x32_bf16 v[156:159], v[28:31], v[44:47], v[156:159]
    s_waitcnt lgkmcnt(4)
    v_mfma_f32_16x16x32_bf16 v[152:155], v[36:39], v[48:51], v[152:155]
    v_mfma_f32_16x16x32_bf16 v[160:163], v[36:39], v[44:47], v[160:163]
    s_waitcnt lgkmcnt(3)
    v_mfma_f32_16x16x32_bf16 v[148:151], v[16:19], v[56:59], v[148:151]
    v_mfma_f32_16x16x32_bf16 v[156:159], v[16:19], v[64:67], v[156:159]
    s_waitcnt lgkmcnt(2)
    v_mfma_f32_16x16x32_bf16 v[152:155], v[24:27], v[56:59], v[152:155]
    v_mfma_f32_16x16x32_bf16 v[160:163], v[24:27], v[64:67], v[160:163]
    s_waitcnt lgkmcnt(1)
    v_mfma_f32_16x16x32_bf16 v[148:151], v[32:35], v[60:63], v[148:151]
    v_mfma_f32_16x16x32_bf16 v[156:159], v[32:35], v[56:59], v[156:159]
    s_waitcnt lgkmcnt(0)
    v_mfma_f32_16x16x32_bf16 v[152:155], v[40:43], v[60:63], v[152:155]
    v_mfma_f32_16x16x32_bf16 v[160:163], v[40:43], v[56:59], v[160:163]
    s_nop 3
    v_mul_f32 v164, v148, v116
    v_mul_f32 v172, v156, v116
    v_mul_f32 v165, v149, v117
    v_mul_f32 v173, v157, v117
    v_mul_f32 v166, v150, v118
    v_mul_f32 v174, v158, v118
    v_mul_f32 v167, v151, v119
    v_mul_f32 v175, v159, v119
    v_mul_f32 v168, v152, v120
    v_mul_f32 v176, v160, v120
    v_mul_f32 v169, v153, v121
    v_mul_f32 v177, v161, v121
    v_mul_f32 v170, v154, v122
    v_mul_f32 v178, v162, v122
    v_mul_f32 v171, v155, v123
    v_mul_f32 v179, v163, v123
    v_fma_f32 v164, v156, v124, v164
    v_fma_f32 v172, v148, -v124, v172
    v_fma_f32 v165, v157, v125, v165
    v_fma_f32 v173, v149, -v125, v173
    v_fma_f32 v166, v158, v126, v166
    v_fma_f32 v174, v150, -v126, v174
    v_fma_f32 v167, v159, v127, v167
    v_fma_f32 v175, v151, -v127, v175
    v_fma_f32 v168, v160, v128, v168
    v_fma_f32 v176, v152, -v128, v176
    v_fma_f32 v169, v161, v129, v169
    v_fma_f32 v177, v153, -v129, v177
    v_fma_f32 v170, v162, v130, v170
    v_fma_f32 v178, v154, -v130, v178
    v_fma_f32 v171, v163, v131, v171
    v_fma_f32 v179, v155, -v131, v179
    v_cvt_pk_bf16_f32 v180, v164, v165
    v_cvt_pk_bf16_f32 v184, v172, v173
    v_cvt_pk_bf16_f32 v181, v166, v167
    v_cvt_pk_bf16_f32 v185, v174, v175
    v_cvt_pk_bf16_f32 v182, v168, v169
    v_cvt_pk_bf16_f32 v186, v176, v177
    v_cvt_pk_bf16_f32 v183, v170, v171
    v_cvt_pk_bf16_f32 v187, v178, v179
    s_nop 0
    v_mfma_f32_16x16x32_bf16 v[148:151], v[68:71], v[180:183], 0
    v_mfma_f32_16x16x32_bf16 v[156:159], v[68:71], v[184:187], 0
    v_mfma_f32_16x16x32_bf16 v[152:155], v[80:83], v[180:183], 0
    v_mfma_f32_16x16x32_bf16 v[160:163], v[80:83], v[184:187], 0
    v_mfma_f32_16x16x32_bf16 v[148:151], v[72:75], v[184:187], v[148:151]
    v_mfma_f32_16x16x32_bf16 v[156:159], v[76:79], v[180:183], v[156:159]
    v_mfma_f32_16x16x32_bf16 v[152:155], v[84:87], v[184:187], v[152:155]
    v_mfma_f32_16x16x32_bf16 v[160:163], v[88:91], v[180:183], v[160:163]
    s_barrier
    s_waitcnt vmcnt(0)
    v_lshlrev_b32 v100, 16, v92
    v_and_b32 v108, 0xffff0000, v92
    v_lshlrev_b32 v101, 16, v93
    v_and_b32 v109, 0xffff0000, v93
    v_lshlrev_b32 v102, 16, v94
    v_and_b32 v110, 0xffff0000, v94
    v_lshlrev_b32 v103, 16, v95
    v_and_b32 v111, 0xffff0000, v95
    v_lshlrev_b32 v104, 16, v96
    v_and_b32 v112, 0xffff0000, v96
    v_lshlrev_b32 v105, 16, v97
    v_and_b32 v113, 0xffff0000, v97
    v_lshlrev_b32 v106, 16, v98
    v_and_b32 v114, 0xffff0000, v98
    v_lshlrev_b32 v107, 16, v99
    v_and_b32 v115, 0xffff0000, v99
    v_mul_f32 v164, v148, v100
    v_mul_f32 v172, v156, v100
    v_mul_f32 v165, v149, v101
    v_mul_f32 v173, v157, v101
    v_mul_f32 v166, v150, v102
    v_mul_f32 v174, v158, v102
    v_mul_f32 v167, v151, v103
    v_mul_f32 v175, v159, v103
    v_mul_f32 v168, v152, v104
    v_mul_f32 v176, v160, v104
    v_mul_f32 v169, v153, v105
    v_mul_f32 v177, v161, v105
    v_mul_f32 v170, v154, v106
    v_mul_f32 v178, v162, v106
    v_mul_f32 v171, v155, v107
    v_mul_f32 v179, v163, v107
    v_fma_f32 v164, v156, -v108, v164
    v_fma_f32 v172, v148, v108, v172
    v_fma_f32 v165, v157, -v109, v165
    v_fma_f32 v173, v149, v109, v173
    v_fma_f32 v166, v158, -v110, v166
    v_fma_f32 v174, v150, v110, v174
    v_fma_f32 v167, v159, -v111, v167
    v_fma_f32 v175, v151, v111, v175
    v_fma_f32 v168, v160, -v112, v168
    v_fma_f32 v176, v152, v112, v176
    v_fma_f32 v169, v161, -v113, v169
    v_fma_f32 v177, v153, v113, v177
    v_fma_f32 v170, v162, -v114, v170
    v_fma_f32 v178, v154, v114, v178
    v_fma_f32 v171, v163, -v115, v171
    v_fma_f32 v179, v155, v115, v179
    v_cvt_pk_bf16_f32 v180, v164, v165
    v_cvt_pk_bf16_f32 v184, v172, v173
    v_cvt_pk_bf16_f32 v181, v166, v167
    v_cvt_pk_bf16_f32 v185, v174, v175
    v_cvt_pk_bf16_f32 v182, v168, v169
    v_cvt_pk_bf16_f32 v186, v176, v177
    v_cvt_pk_bf16_f32 v183, v170, v171
    v_cvt_pk_bf16_f32 v187, v178, v179
    s_nop 0
    v_mfma_f32_16x16x32_bf16 v[148:151], v[180:183], v[68:71], 0
    v_mfma_f32_16x16x32_bf16 v[156:159], v[184:187], v[68:71], 0
    v_mfma_f32_16x16x32_bf16 v[152:155], v[180:183], v[80:83], 0
    v_mfma_f32_16x16x32_bf16 v[160:163], v[184:187], v[80:83], 0
    v_mfma_f32_16x16x32_bf16 v[148:151], v[184:187], v[76:79], v[148:151]
    v_mfma_f32_16x16x32_bf16 v[156:159], v[180:183], v[72:75], v[156:159]
    v_mfma_f32_16x16x32_bf16 v[152:155], v[184:187], v[88:91], v[152:155]
    v_mfma_f32_16x16x32_bf16 v[160:163], v[180:183], v[84:87], v[160:163]
    s_nop 4
    v_mul_f32 v164, v148, v132
    v_mul_f32 v172, v156, v132
    v_mul_f32 v165, v149, v133
    v_mul_f32 v173, v157, v133
    v_mul_f32 v166, v150, v134
    v_mul_f32 v174, v158, v134
    v_mul_f32 v167, v151, v135
    v_mul_f32 v175, v159, v135
    v_mul_f32 v168, v152, v136
    v_mul_f32 v176, v160, v136
    v_mul_f32 v169, v153, v137
    v_mul_f32 v177, v161, v137
    v_mul_f32 v170, v154, v138
    v_mul_f32 v178, v162, v138
    v_mul_f32 v171, v155, v139
    v_mul_f32 v179, v163, v139
    v_fma_f32 v164, v156, -v140, v164
    v_fma_f32 v172, v148, v140, v172
    v_fma_f32 v165, v157, -v141, v165
    v_fma_f32 v173, v149, v141, v173
    v_fma_f32 v166, v158, -v142, v166
    v_fma_f32 v174, v150, v142, v174
    v_fma_f32 v167, v159, -v143, v167
    v_fma_f32 v175, v151, v143, v175
    v_fma_f32 v168, v160, -v144, v168
    v_fma_f32 v176, v152, v144, v176
    v_fma_f32 v169, v161, -v145, v169
    v_fma_f32 v177, v153, v145, v177
    v_fma_f32 v170, v162, -v146, v170
    v_fma_f32 v178, v154, v146, v178
    v_fma_f32 v171, v163, -v147, v171
    v_fma_f32 v179, v155, v147, v179
    v_cvt_pk_bf16_f32 v180, v164, v165
    v_cvt_pk_bf16_f32 v184, v172, v173
    v_cvt_pk_bf16_f32 v181, v166, v167
    v_cvt_pk_bf16_f32 v185, v174, v175
    v_cvt_pk_bf16_f32 v182, v168, v169
    v_cvt_pk_bf16_f32 v186, v176, v177
    v_cvt_pk_bf16_f32 v183, v170, v171
    v_cvt_pk_bf16_f32 v187, v178, v179
    ds_write_b64 v10, v[180:181] offset:0
    ds_write_b64 v10, v[184:185] offset:4096
    ds_write_b64 v10, v[182:183] offset:2048
    ds_write_b64 v10, v[186:187] offset:6144
    s_waitcnt lgkmcnt(0)
    s_barrier
    ds_read_b128 v[12:15], v5 offset:0
    ds_read_b128 v[20:23], v5 offset:2048
    ds_read_b128 v[28:31], v5 offset:4096
    ds_read_b128 v[36:39], v5 offset:6144
    ds_read_b128 v[16:19], v5 offset:1024
    ds_read_b128 v[24:27], v5 offset:3072
    ds_read_b128 v[32:35], v5 offset:5120
    ds_read_b128 v[40:43], v5 offset:7168
    s_waitcnt lgkmcnt(7)
    v_mfma_f32_16x16x32_bf16 v[148:151], v[44:47], v[12:15], 0
    v_mfma_f32_16x16x32_bf16 v[156:159], v[48:51], v[12:15], 0
    s_waitcnt lgkmcnt(6)
    v_mfma_f32_16x16x32_bf16 v[152:155], v[44:47], v[20:23], 0
    v_mfma_f32_16x16x32_bf16 v[160:163], v[48:51], v[20:23], 0
    s_waitcnt lgkmcnt(5)
    v_mfma_f32_16x16x32_bf16 v[148:151], v[52:55], v[28:31], v[148:151]
    v_mfma_f32_16x16x32_bf16 v[156:159], v[44:47], v[28:31], v[156:159]
    s_waitcnt lgkmcnt(4)
    v_mfma_f32_16x16x32_bf16 v[152:155], v[52:55], v[36:39], v[152:155]
    v_mfma_f32_16x16x32_bf16 v[160:163], v[44:47], v[36:39], v[160:163]
    s_waitcnt lgkmcnt(3)
    v_mfma_f32_16x16x32_bf16 v[148:151], v[56:59], v[16:19], v[148:151]
    v_mfma_f32_16x16x32_bf16 v[156:159], v[60:63], v[16:19], v[156:159]
    s_waitcnt lgkmcnt(2)
    v_mfma_f32_16x16x32_bf16 v[152:155], v[56:59], v[24:27], v[152:155]
    v_mfma_f32_16x16x32_bf16 v[160:163], v[60:63], v[24:27], v[160:163]
    s_waitcnt lgkmcnt(1)
    v_mfma_f32_16x16x32_bf16 v[148:151], v[64:67], v[32:35], v[148:151]
    v_mfma_f32_16x16x32_bf16 v[156:159], v[56:59], v[32:35], v[156:159]
    s_waitcnt lgkmcnt(0)
    v_mfma_f32_16x16x32_bf16 v[152:155], v[64:67], v[40:43], v[152:155]
    v_mfma_f32_16x16x32_bf16 v[160:163], v[56:59], v[40:43], v[160:163]
    s_nop 3
    v_cvt_pk_bf16_f32 v180, v148, v149
    v_cvt_pk_bf16_f32 v184, v156, v157
    v_cvt_pk_bf16_f32 v181, v150, v151
    v_cvt_pk_bf16_f32 v185, v158, v159
    v_cvt_pk_bf16_f32 v182, v152, v153
    v_cvt_pk_bf16_f32 v186, v160, v161
    v_cvt_pk_bf16_f32 v183, v154, v155
    v_cvt_pk_bf16_f32 v187, v162, v163
    s_barrier
    s_barrier
    s_barrier
    buffer_store_dwordx2 v[180:181], v9, s[44:47], s8 offen offset:0 sc0 sc1
    buffer_store_dwordx2 v[184:185], v9, s[44:47], s9 offen offset:0 sc0 sc1
    buffer_store_dwordx2 v[182:183], v9, s[44:47], s8 offen offset:2048 sc0 sc1
    buffer_store_dwordx2 v[186:187], v9, s[44:47], s9 offen offset:2048 sc0 sc1
    s_barrier
    s_endpgm
k2_kernel_end:
    s_endpgm
.globl k3_kernel
.p2align 8
.type k3_kernel,@function
k3_kernel:
    s_cmp_ge_u32 s2, 256
    s_cbranch_scc1 k3_kernel_end
    s_load_dwordx16 s[16:31], s[0:1], 0
    s_load_dwordx2 s[32:33], s[0:1], 64
    s_load_dwordx2 s[34:35], s[0:1], 80
    s_getpc_b64 s[36:37]
k3_kernel_pc:
    v_lshlrev_b32 v191, 7, v0
    v_min_u32 v191, code_end-k3_kernel_pc-4, v191
    global_load_dword v191, v191, s[36:37]
    v_lshrrev_b32 v2, 6, v0
    v_and_b32 v1, 63, v0
    v_readfirstlane_b32 s3, v2
    s_nop 3
    s_and_b32 s4, s2, 7
    s_bfe_u32 s6, s2, 0x20003
    s_lshl_b32 s8, s4, 2
    s_add_u32 s8, s8, s6
    s_bfe_u32 s5, s2, 0x10005
    s_lshr_b32 s7, s2, 6
    s_lshl_b32 s9, s7, 2
    s_min_u32 s9, s9, 10
    s_and_b32 s4, s3, 3
    s_add_u32 s9, s9, s4
    s_lshl_b32 s61, s8, 1
    s_add_u32 s61, s61, s5
    s_lshl_b32 s12, s4, 12
    s_add_u32 s12, s12, 28672
    v_and_b32 v2, 31, v1
    v_lshrrev_b32 v10, 5, v1
    v_lshlrev_b32 v6, 4, v1
    v_add_u32 v12, s12, v6
    s_cmp_ge_u32 s3, 4
    s_cbranch_scc1 k3_epi
    v_lshrrev_b32 v4, 2, v1
    v_and_b32 v3, 3, v1
    v_lshlrev_b32 v3, 4, v3
    v_lshl_add_u32 v7, v4, 12, v3
    s_lshl_b32 s13, s3, 16
    s_lshl_b32 s14, s61, 6
    s_add_u32 s13, s13, s14
    s_add_u32 s13, s13, 14680064
    s_lshl_b32 s57, s3, 10
    s_mov_b32 s15, 0x3b124925
    s_mov_b32 s60, 0xc3e00000
    s_lshl_b32 s10, s9, 5
    v_add_u32 v4, s10, v2
    v_cvt_f32_u32 v4, v4
    v_lshlrev_b32 v5, 1, v10
    v_cmp_eq_u32 vcc, 0, v5
    v_cvt_f32_u32 v5, v5
    v_add_f32 v16, 0x00000000, v5
    v_add_f32 v17, 0x3f800000, v5
    v_add_f32 v18, 0x40800000, v5
    v_add_f32 v19, 0x40a00000, v5
    v_mul_f32 v16, v16, v4
    v_mul_f32 v17, v17, v4
    v_mul_f32 v18, v18, v4
    v_mul_f32 v19, v19, v4
    v_mul_f32 v5, 0x41000000, v4
    v_mul_f32 v20, s15, v16
    v_mul_f32 v21, s15, v17
    v_mul_f32 v22, s15, v18
    v_mul_f32 v23, s15, v19
    v_mul_f32 v3, s15, v5
    v_floor_f32 v20, v20
    v_floor_f32 v21, v21
    v_floor_f32 v22, v22
    v_floor_f32 v23, v23
    v_floor_f32 v3, v3
    v_fma_f32 v16, v20, s60, v16
    v_fma_f32 v17, v21, s60, v17
    v_fma_f32 v18, v22, s60, v18
    v_fma_f32 v19, v23, s60, v19
    v_fma_f32 v5, v3, s60, v5
    v_mul_f32 v16, s15, v16
    v_mul_f32 v17, s15, v17
    v_mul_f32 v18, s15, v18
    v_mul_f32 v19, s15, v19
    v_mul_f32 v5, s15, v5
    v_lshlrev_b32 v11, 31, v1
    v_or_b32 v11, 0x3f003f00, v11
    v_cos_f32 v14, v5
    v_sin_f32 v15, v5
    v_cos_f32 v24, v16
    v_sin_f32 v25, -v16
    v_cos_f32 v26, v17
    v_sin_f32 v27, -v17
    v_cos_f32 v28, v18
    v_sin_f32 v29, -v18
    v_cos_f32 v30, v19
    v_sin_f32 v31, -v19
    v_cvt_pk_bf16_f32 v72, v24, v25
    v_cvt_pk_bf16_f32 v73, v26, v27
    v_cvt_pk_bf16_f32 v74, v28, v29
    v_cvt_pk_bf16_f32 v75, v30, v31
    v_cndmask_b32 v72, v72, v11, vcc
    v_add_f32 v14, v14, v14
    v_add_f32 v16, v5, v16
    v_add_f32 v17, v5, v17
    v_add_f32 v18, v5, v18
    v_add_f32 v19, v5, v19
    v_cos_f32 v32, v16
    v_sin_f32 v33, -v16
    v_cos_f32 v34, v17
    v_sin_f32 v35, -v17
    v_cos_f32 v36, v18
    v_sin_f32 v37, -v18
    v_cos_f32 v38, v19
    v_sin_f32 v39, -v19
    v_cvt_pk_bf16_f32 v76, v32, v33
    v_cvt_pk_bf16_f32 v77, v34, v35
    v_cvt_pk_bf16_f32 v78, v36, v37
    v_cvt_pk_bf16_f32 v79, v38, v39
    v_pk_fma_f32 v[24:25], v[32:33], v[14:15], v[24:25] op_sel:[0,0,0] op_sel_hi:[1,0,1] neg_lo:[0,0,1] neg_hi:[0,0,1]
    v_pk_fma_f32 v[26:27], v[34:35], v[14:15], v[26:27] op_sel:[0,0,0] op_sel_hi:[1,0,1] neg_lo:[0,0,1] neg_hi:[0,0,1]
    v_pk_fma_f32 v[28:29], v[36:37], v[14:15], v[28:29] op_sel:[0,0,0] op_sel_hi:[1,0,1] neg_lo:[0,0,1] neg_hi:[0,0,1]
    v_pk_fma_f32 v[30:31], v[38:39], v[14:15], v[30:31] op_sel:[0,0,0] op_sel_hi:[1,0,1] neg_lo:[0,0,1] neg_hi:[0,0,1]
    v_cvt_pk_bf16_f32 v80, v24, v25
    v_cvt_pk_bf16_f32 v81, v26, v27
    v_cvt_pk_bf16_f32 v82, v28, v29
    v_cvt_pk_bf16_f32 v83, v30, v31
    s_waitcnt lgkmcnt(0)
    s_mov_b32 s44, s34
    s_and_b32 s45, s35, 0xffff
    s_mov_b32 s46, 268435456
    s_mov_b32 s47, 0x00020000
    s_add_u32 m0, s57, 0
    s_nop 0
    buffer_load_dwordx4 v7, s[44:47], s13 offen lds
    s_add_u32 m0, s57, 4096
    s_add_u32 s13, s13, 262144
    buffer_load_dwordx4 v7, s[44:47], s13 offen lds
    s_add_u32 m0, s57, 8192
    s_add_u32 s13, s13, 262144
    buffer_load_dwordx4 v7, s[44:47], s13 offen lds
    s_add_u32 m0, s57, 12288
    s_add_u32 s13, s13, 262144
    buffer_load_dwordx4 v7, s[44:47], s13 offen lds
    s_add_u32 m0, s57, 16384
    s_add_u32 s13, s13, 262144
    buffer_load_dwordx4 v7, s[44:47], s13 offen lds
    s_add_u32 m0, s57, 20480
    s_add_u32 s13, s13, 262144
    buffer_load_dwordx4 v7, s[44:47], s13 offen lds
    s_add_u32 m0, s57, 24576
    s_add_u32 s13, s13, 262144
    buffer_load_dwordx4 v7, s[44:47], s13 offen lds
    v_pk_fma_f32 v[32:33], v[24:25], v[14:15], v[32:33] op_sel:[0,0,0] op_sel_hi:[1,0,1] neg_lo:[0,0,1] neg_hi:[0,0,1]
    v_pk_fma_f32 v[34:35], v[26:27], v[14:15], v[34:35] op_sel:[0,0,0] op_sel_hi:[1,0,1] neg_lo:[0,0,1] neg_hi:[0,0,1]
    v_pk_fma_f32 v[36:37], v[28:29], v[14:15], v[36:37] op_sel:[0,0,0] op_sel_hi:[1,0,1] neg_lo:[0,0,1] neg_hi:[0,0,1]
    v_pk_fma_f32 v[38:39], v[30:31], v[14:15], v[38:39] op_sel:[0,0,0] op_sel_hi:[1,0,1] neg_lo:[0,0,1] neg_hi:[0,0,1]
    v_cvt_pk_bf16_f32 v84, v32, v33
    v_cvt_pk_bf16_f32 v85, v34, v35
    v_cvt_pk_bf16_f32 v86, v36, v37
    v_cvt_pk_bf16_f32 v87, v38, v39
    v_pk_fma_f32 v[24:25], v[32:33], v[14:15], v[24:25] op_sel:[0,0,0] op_sel_hi:[1,0,1] neg_lo:[0,0,1] neg_hi:[0,0,1]
    v_pk_fma_f32 v[26:27], v[34:35], v[14:15], v[26:27] op_sel:[0,0,0] op_sel_hi:[1,0,1] neg_lo:[0,0,1] neg_hi:[0,0,1]
    v_pk_fma_f32 v[28:29], v[36:37], v[14:15], v[28:29] op_sel:[0,0,0] op_sel_hi:[1,0,1] neg_lo:[0,0,1] neg_hi:[0,0,1]
    v_pk_fma_f32 v[30:31], v[38:39], v[14:15], v[30:31] op_sel:[0,0,0] op_sel_hi:[1,0,1] neg_lo:[0,0,1] neg_hi:[0,0,1]
    v_cvt_pk_bf16_f32 v88, v24, v25
    v_cvt_pk_bf16_f32 v89, v26, v27
    v_cvt_pk_bf16_f32 v90, v28, v29
    v_cvt_pk_bf16_f32 v91, v30, v31
    v_pk_fma_f32 v[32:33], v[24:25], v[14:15], v[32:33] op_sel:[0,0,0] op_sel_hi:[1,0,1] neg_lo:[0,0,1] neg_hi:[0,0,1]
    v_pk_fma_f32 v[34:35], v[26:27], v[14:15], v[34:35] op_sel:[0,0,0] op_sel_hi:[1,0,1] neg_lo:[0,0,1] neg_hi:[0,0,1]
    v_pk_fma_f32 v[36:37], v[28:29], v[14:15], v[36:37] op_sel:[0,0,0] op_sel_hi:[1,0,1] neg_lo:[0,0,1] neg_hi:[0,0,1]
    v_pk_fma_f32 v[38:39], v[30:31], v[14:15], v[38:39] op_sel:[0,0,0] op_sel_hi:[1,0,1] neg_lo:[0,0,1] neg_hi:[0,0,1]
    v_cvt_pk_bf16_f32 v92, v32, v33
    v_cvt_pk_bf16_f32 v93, v34, v35
    v_cvt_pk_bf16_f32 v94, v36, v37
    v_cvt_pk_bf16_f32 v95, v38, v39
    v_pk_fma_f32 v[24:25], v[32:33], v[14:15], v[24:25] op_sel:[0,0,0] op_sel_hi:[1,0,1] neg_lo:[0,0,1] neg_hi:[0,0,1]
    v_pk_fma_f32 v[26:27], v[34:35], v[14:15], v[26:27] op_sel:[0,0,0] op_sel_hi:[1,0,1] neg_lo:[0,0,1] neg_hi:[0,0,1]
    v_pk_fma_f32 v[28:29], v[36:37], v[14:15], v[28:29] op_sel:[0,0,0] op_sel_hi:[1,0,1] neg_lo:[0,0,1] neg_hi:[0,0,1]
    v_pk_fma_f32 v[30:31], v[38:39], v[14:15], v[30:31] op_sel:[0,0,0] op_sel_hi:[1,0,1] neg_lo:[0,0,1] neg_hi:[0,0,1]
    v_cvt_pk_bf16_f32 v96, v24, v25
    v_cvt_pk_bf16_f32 v97, v26, v27
    v_cvt_pk_bf16_f32 v98, v28, v29
    v_cvt_pk_bf16_f32 v99, v30, v31
    v_pk_fma_f32 v[32:33], v[24:25], v[14:15], v[32:33] op_sel:[0,0,0] op_sel_hi:[1,0,1] neg_lo:[0,0,1] neg_hi:[0,0,1]
    v_pk_fma_f32 v[34:35], v[26:27], v[14:15], v[34:35] op_sel:[0,0,0] op_sel_hi:[1,0,1] neg_lo:[0,0,1] neg_hi:[0,0,1]
    v_pk_fma_f32 v[36:37], v[28:29], v[14:15], v[36:37] op_sel:[0,0,0] op_sel_hi:[1,0,1] neg_lo:[0,0,1] neg_hi:[0,0,1]
    v_pk_fma_f32 v[38:39], v[30:31], v[14:15], v[38:39] op_sel:[0,0,0] op_sel_hi:[1,0,1] neg_lo:[0,0,1] neg_hi:[0,0,1]
    v_cvt_pk_bf16_f32 v100, v32, v33
    v_cvt_pk_bf16_f32 v101, v34, v35
    v_cvt_pk_bf16_f32 v102, v36, v37
    v_cvt_pk_bf16_f32 v103, v38, v39
    v_pk_fma_f32 v[24:25], v[32:33], v[14:15], v[24:25] op_sel:[0,0,0] op_sel_hi:[1,0,1] neg_lo:[0,0,1] neg_hi:[0,0,1]
    v_pk_fma_f32 v[26:27], v[34:35], v[14:15], v[26:27] op_sel:[0,0,0] op_sel_hi:[1,0,1] neg_lo:[0,0,1] neg_hi:[0,0,1]
    v_pk_fma_f32 v[28:29], v[36:37], v[14:15], v[28:29] op_sel:[0,0,0] op_sel_hi:[1,0,1] neg_lo:[0,0,1] neg_hi:[0,0,1]
    v_pk_fma_f32 v[30:31], v[38:39], v[14:15], v[30:31] op_sel:[0,0,0] op_sel_hi:[1,0,1] neg_lo:[0,0,1] neg_hi:[0,0,1]
    v_cvt_pk_bf16_f32 v104, v24, v25
    v_cvt_pk_bf16_f32 v105, v26, v27
    v_cvt_pk_bf16_f32 v106, v28, v29
    v_cvt_pk_bf16_f32 v107, v30, v31
    v_pk_fma_f32 v[32:33], v[24:25], v[14:15], v[32:33] op_sel:[0,0,0] op_sel_hi:[1,0,1] neg_lo:[0,0,1] neg_hi:[0,0,1]
    v_pk_fma_f32 v[34:35], v[26:27], v[14:15], v[34:35] op_sel:[0,0,0] op_sel_hi:[1,0,1] neg_lo:[0,0,1] neg_hi:[0,0,1]
    v_pk_fma_f32 v[36:37], v[28:29], v[14:15], v[36:37] op_sel:[0,0,0] op_sel_hi:[1,0,1] neg_lo:[0,0,1] neg_hi:[0,0,1]
    v_pk_fma_f32 v[38:39], v[30:31], v[14:15], v[38:39] op_sel:[0,0,0] op_sel_hi:[1,0,1] neg_lo:[0,0,1] neg_hi:[0,0,1]
    v_cvt_pk_bf16_f32 v108, v32, v33
    v_cvt_pk_bf16_f32 v109, v34, v35
    v_cvt_pk_bf16_f32 v110, v36, v37
    v_cvt_pk_bf16_f32 v111, v38, v39
    v_pk_fma_f32 v[24:25], v[32:33], v[14:15], v[24:25] op_sel:[0,0,0] op_sel_hi:[1,0,1] neg_lo:[0,0,1] neg_hi:[0,0,1]
    v_pk_fma_f32 v[26:27], v[34:35], v[14:15], v[26:27] op_sel:[0,0,0] op_sel_hi:[1,0,1] neg_lo:[0,0,1] neg_hi:[0,0,1]
    v_pk_fma_f32 v[28:29], v[36:37], v[14:15], v[28:29] op_sel:[0,0,0] op_sel_hi:[1,0,1] neg_lo:[0,0,1] neg_hi:[0,0,1]
    v_pk_fma_f32 v[30:31], v[38:39], v[14:15], v[30:31] op_sel:[0,0,0] op_sel_hi:[1,0,1] neg_lo:[0,0,1] neg_hi:[0,0,1]
    v_cvt_pk_bf16_f32 v112, v24, v25
    v_cvt_pk_bf16_f32 v113, v26, v27
    v_cvt_pk_bf16_f32 v114, v28, v29
    v_cvt_pk_bf16_f32 v115, v30, v31
    v_pk_fma_f32 v[32:33], v[24:25], v[14:15], v[32:33] op_sel:[0,0,0] op_sel_hi:[1,0,1] neg_lo:[0,0,1] neg_hi:[0,0,1]
    v_pk_fma_f32 v[34:35], v[26:27], v[14:15], v[34:35] op_sel:[0,0,0] op_sel_hi:[1,0,1] neg_lo:[0,0,1] neg_hi:[0,0,1]
    v_pk_fma_f32 v[36:37], v[28:29], v[14:15], v[36:37] op_sel:[0,0,0] op_sel_hi:[1,0,1] neg_lo:[0,0,1] neg_hi:[0,0,1]
    v_pk_fma_f32 v[38:39], v[30:31], v[14:15], v[38:39] op_sel:[0,0,0] op_sel_hi:[1,0,1] neg_lo:[0,0,1] neg_hi:[0,0,1]
    v_cvt_pk_bf16_f32 v116, v32, v33
    v_cvt_pk_bf16_f32 v117, v34, v35
    v_cvt_pk_bf16_f32 v118, v36, v37
    v_cvt_pk_bf16_f32 v119, v38, v39
    v_pk_fma_f32 v[24:25], v[32:33], v[14:15], v[24:25] op_sel:[0,0,0] op_sel_hi:[1,0,1] neg_lo:[0,0,1] neg_hi:[0,0,1]
    v_pk_fma_f32 v[26:27], v[34:35], v[14:15], v[26:27] op_sel:[0,0,0] op_sel_hi:[1,0,1] neg_lo:[0,0,1] neg_hi:[0,0,1]
    v_pk_fma_f32 v[28:29], v[36:37], v[14:15], v[28:29] op_sel:[0,0,0] op_sel_hi:[1,0,1] neg_lo:[0,0,1] neg_hi:[0,0,1]
    v_pk_fma_f32 v[30:31], v[38:39], v[14:15], v[30:31] op_sel:[0,0,0] op_sel_hi:[1,0,1] neg_lo:[0,0,1] neg_hi:[0,0,1]
    v_cvt_pk_bf16_f32 v120, v24, v25
    v_cvt_pk_bf16_f32 v121, v26, v27
    v_cvt_pk_bf16_f32 v122, v28, v29
    v_cvt_pk_bf16_f32 v123, v30, v31
    v_pk_fma_f32 v[32:33], v[24:25], v[14:15], v[32:33] op_sel:[0,0,0] op_sel_hi:[1,0,1] neg_lo:[0,0,1] neg_hi:[0,0,1]
    v_pk_fma_f32 v[34:35], v[26:27], v[14:15], v[34:35] op_sel:[0,0,0] op_sel_hi:[1,0,1] neg_lo:[0,0,1] neg_hi:[0,0,1]
    v_pk_fma_f32 v[36:37], v[28:29], v[14:15], v[36:37] op_sel:[0,0,0] op_sel_hi:[1,0,1] neg_lo:[0,0,1] neg_hi:[0,0,1]
    v_pk_fma_f32 v[38:39], v[30:31], v[14:15], v[38:39] op_sel:[0,0,0] op_sel_hi:[1,0,1] neg_lo:[0,0,1] neg_hi:[0,0,1]
    v_cvt_pk_bf16_f32 v124, v32, v33
    v_cvt_pk_bf16_f32 v125, v34, v35
    v_cvt_pk_bf16_f32 v126, v36, v37
    v_cvt_pk_bf16_f32 v127, v38, v39
    v_pk_fma_f32 v[24:25], v[32:33], v[14:15], v[24:25] op_sel:[0,0,0] op_sel_hi:[1,0,1] neg_lo:[0,0,1] neg_hi:[0,0,1]
    v_pk_fma_f32 v[26:27], v[34:35], v[14:15], v[26:27] op_sel:[0,0,0] op_sel_hi:[1,0,1] neg_lo:[0,0,1] neg_hi:[0,0,1]
    v_pk_fma_f32 v[28:29], v[36:37], v[14:15], v[28:29] op_sel:[0,0,0] op_sel_hi:[1,0,1] neg_lo:[0,0,1] neg_hi:[0,0,1]
    v_pk_fma_f32 v[30:31], v[38:39], v[14:15], v[30:31] op_sel:[0,0,0] op_sel_hi:[1,0,1] neg_lo:[0,0,1] neg_hi:[0,0,1]
    v_cvt_pk_bf16_f32 v128, v24, v25
    v_cvt_pk_bf16_f32 v129, v26, v27
    v_cvt_pk_bf16_f32 v130, v28, v29
    v_cvt_pk_bf16_f32 v131, v30, v31
    v_pk_fma_f32 v[32:33], v[24:25], v[14:15], v[32:33] op_sel:[0,0,0] op_sel_hi:[1,0,1] neg_lo:[0,0,1] neg_hi:[0,0,1]
    v_pk_fma_f32 v[34:35], v[26:27], v[14:15], v[34:35] op_sel:[0,0,0] op_sel_hi:[1,0,1] neg_lo:[0,0,1] neg_hi:[0,0,1]
    v_pk_fma_f32 v[36:37], v[28:29], v[14:15], v[36:37] op_sel:[0,0,0] op_sel_hi:[1,0,1] neg_lo:[0,0,1] neg_hi:[0,0,1]
    v_pk_fma_f32 v[38:39], v[30:31], v[14:15], v[38:39] op_sel:[0,0,0] op_sel_hi:[1,0,1] neg_lo:[0,0,1] neg_hi:[0,0,1]
    v_cvt_pk_bf16_f32 v132, v32, v33
    v_cvt_pk_bf16_f32 v133, v34, v35
    v_cvt_pk_bf16_f32 v134, v36, v37
    v_cvt_pk_bf16_f32 v135, v38, v39
    v_pk_fma_f32 v[24:25], v[32:33], v[14:15], v[24:25] op_sel:[0,0,0] op_sel_hi:[1,0,1] neg_lo:[0,0,1] neg_hi:[0,0,1]
    v_pk_fma_f32 v[26:27], v[34:35], v[14:15], v[26:27] op_sel:[0,0,0] op_sel_hi:[1,0,1] neg_lo:[0,0,1] neg_hi:[0,0,1]
    v_pk_fma_f32 v[28:29], v[36:37], v[14:15], v[28:29] op_sel:[0,0,0] op_sel_hi:[1,0,1] neg_lo:[0,0,1] neg_hi:[0,0,1]
    v_pk_fma_f32 v[30:31], v[38:39], v[14:15], v[30:31] op_sel:[0,0,0] op_sel_hi:[1,0,1] neg_lo:[0,0,1] neg_hi:[0,0,1]
    v_cvt_pk_bf16_f32 v136, v24, v25
    v_cvt_pk_bf16_f32 v137, v26, v27
    v_cvt_pk_bf16_f32 v138, v28, v29
    v_cvt_pk_bf16_f32 v139, v30, v31
    v_pk_fma_f32 v[32:33], v[24:25], v[14:15], v[32:33] op_sel:[0,0,0] op_sel_hi:[1,0,1] neg_lo:[0,0,1] neg_hi:[0,0,1]
    v_pk_fma_f32 v[34:35], v[26:27], v[14:15], v[34:35] op_sel:[0,0,0] op_sel_hi:[1,0,1] neg_lo:[0,0,1] neg_hi:[0,0,1]
    v_pk_fma_f32 v[36:37], v[28:29], v[14:15], v[36:37] op_sel:[0,0,0] op_sel_hi:[1,0,1] neg_lo:[0,0,1] neg_hi:[0,0,1]
    v_pk_fma_f32 v[38:39], v[30:31], v[14:15], v[38:39] op_sel:[0,0,0] op_sel_hi:[1,0,1] neg_lo:[0,0,1] neg_hi:[0,0,1]
    v_cvt_pk_bf16_f32 v140, v32, v33
    v_cvt_pk_bf16_f32 v141, v34, v35
    v_cvt_pk_bf16_f32 v142, v36, v37
    v_cvt_pk_bf16_f32 v143, v38, v39
    v_pk_fma_f32 v[24:25], v[32:33], v[14:15], v[24:25] op_sel:[0,0,0] op_sel_hi:[1,0,1] neg_lo:[0,0,1] neg_hi:[0,0,1]
    v_pk_fma_f32 v[26:27], v[34:35], v[14:15], v[26:27] op_sel:[0,0,0] op_sel_hi:[1,0,1] neg_lo:[0,0,1] neg_hi:[0,0,1]
    v_pk_fma_f32 v[28:29], v[36:37], v[14:15], v[28:29] op_sel:[0,0,0] op_sel_hi:[1,0,1] neg_lo:[0,0,1] neg_hi:[0,0,1]
    v_pk_fma_f32 v[30:31], v[38:39], v[14:15], v[30:31] op_sel:[0,0,0] op_sel_hi:[1,0,1] neg_lo:[0,0,1] neg_hi:[0,0,1]
    v_cvt_pk_bf16_f32 v144, v24, v25
    v_cvt_pk_bf16_f32 v145, v26, v27
    v_cvt_pk_bf16_f32 v146, v28, v29
    v_cvt_pk_bf16_f32 v147, v30, v31
    v_pk_fma_f32 v[32:33], v[24:25], v[14:15], v[32:33] op_sel:[0,0,0] op_sel_hi:[1,0,1] neg_lo:[0,0,1] neg_hi:[0,0,1]
    v_pk_fma_f32 v[34:35], v[26:27], v[14:15], v[34:35] op_sel:[0,0,0] op_sel_hi:[1,0,1] neg_lo:[0,0,1] neg_hi:[0,0,1]
    v_pk_fma_f32 v[36:37], v[28:29], v[14:15], v[36:37] op_sel:[0,0,0] op_sel_hi:[1,0,1] neg_lo:[0,0,1] neg_hi:[0,0,1]
    v_pk_fma_f32 v[38:39], v[30:31], v[14:15], v[38:39] op_sel:[0,0,0] op_sel_hi:[1,0,1] neg_lo:[0,0,1] neg_hi:[0,0,1]
    v_cvt_pk_bf16_f32 v148, v32, v33
    v_cvt_pk_bf16_f32 v149, v34, v35
    v_cvt_pk_bf16_f32 v150, v36, v37
    v_cvt_pk_bf16_f32 v151, v38, v39
    v_pk_fma_f32 v[24:25], v[32:33], v[14:15], v[24:25] op_sel:[0,0,0] op_sel_hi:[1,0,1] neg_lo:[0,0,1] neg_hi:[0,0,1]
    v_pk_fma_f32 v[26:27], v[34:35], v[14:15], v[26:27] op_sel:[0,0,0] op_sel_hi:[1,0,1] neg_lo:[0,0,1] neg_hi:[0,0,1]
    v_pk_fma_f32 v[28:29], v[36:37], v[14:15], v[28:29] op_sel:[0,0,0] op_sel_hi:[1,0,1] neg_lo:[0,0,1] neg_hi:[0,0,1]
    v_pk_fma_f32 v[30:31], v[38:39], v[14:15], v[30:31] op_sel:[0,0,0] op_sel_hi:[1,0,1] neg_lo:[0,0,1] neg_hi:[0,0,1]
    v_cvt_pk_bf16_f32 v152, v24, v25
    v_cvt_pk_bf16_f32 v153, v26, v27
    v_cvt_pk_bf16_f32 v154, v28, v29
    v_cvt_pk_bf16_f32 v155, v30, v31
    v_pk_fma_f32 v[32:33], v[24:25], v[14:15], v[32:33] op_sel:[0,0,0] op_sel_hi:[1,0,1] neg_lo:[0,0,1] neg_hi:[0,0,1]
    v_pk_fma_f32 v[34:35], v[26:27], v[14:15], v[34:35] op_sel:[0,0,0] op_sel_hi:[1,0,1] neg_lo:[0,0,1] neg_hi:[0,0,1]
    v_pk_fma_f32 v[36:37], v[28:29], v[14:15], v[36:37] op_sel:[0,0,0] op_sel_hi:[1,0,1] neg_lo:[0,0,1] neg_hi:[0,0,1]
    v_pk_fma_f32 v[38:39], v[30:31], v[14:15], v[38:39] op_sel:[0,0,0] op_sel_hi:[1,0,1] neg_lo:[0,0,1] neg_hi:[0,0,1]
    v_cvt_pk_bf16_f32 v156, v32, v33
    v_cvt_pk_bf16_f32 v157, v34, v35
    v_cvt_pk_bf16_f32 v158, v36, v37
    v_cvt_pk_bf16_f32 v159, v38, v39
    v_pk_fma_f32 v[24:25], v[32:33], v[14:15], v[24:25] op_sel:[0,0,0] op_sel_hi:[1,0,1] neg_lo:[0,0,1] neg_hi:[0,0,1]
    v_pk_fma_f32 v[26:27], v[34:35], v[14:15], v[26:27] op_sel:[0,0,0] op_sel_hi:[1,0,1] neg_lo:[0,0,1] neg_hi:[0,0,1]
    v_pk_fma_f32 v[28:29], v[36:37], v[14:15], v[28:29] op_sel:[0,0,0] op_sel_hi:[1,0,1] neg_lo:[0,0,1] neg_hi:[0,0,1]
    v_pk_fma_f32 v[30:31], v[38:39], v[14:15], v[30:31] op_sel:[0,0,0] op_sel_hi:[1,0,1] neg_lo:[0,0,1] neg_hi:[0,0,1]
    v_cvt_pk_bf16_f32 v160, v24, v25
    v_cvt_pk_bf16_f32 v161, v26, v27
    v_cvt_pk_bf16_f32 v162, v28, v29
    v_cvt_pk_bf16_f32 v163, v30, v31
    v_pk_fma_f32 v[32:33], v[24:25], v[14:15], v[32:33] op_sel:[0,0,0] op_sel_hi:[1,0,1] neg_lo:[0,0,1] neg_hi:[0,0,1]
    v_pk_fma_f32 v[34:35], v[26:27], v[14:15], v[34:35] op_sel:[0,0,0] op_sel_hi:[1,0,1] neg_lo:[0,0,1] neg_hi:[0,0,1]
    v_pk_fma_f32 v[36:37], v[28:29], v[14:15], v[36:37] op_sel:[0,0,0] op_sel_hi:[1,0,1] neg_lo:[0,0,1] neg_hi:[0,0,1]
    v_pk_fma_f32 v[38:39], v[30:31], v[14:15], v[38:39] op_sel:[0,0,0] op_sel_hi:[1,0,1] neg_lo:[0,0,1] neg_hi:[0,0,1]
    v_cvt_pk_bf16_f32 v164, v32, v33
    v_cvt_pk_bf16_f32 v165, v34, v35
    v_cvt_pk_bf16_f32 v166, v36, v37
    v_cvt_pk_bf16_f32 v167, v38, v39
    v_pk_fma_f32 v[24:25], v[32:33], v[14:15], v[24:25] op_sel:[0,0,0] op_sel_hi:[1,0,1] neg_lo:[0,0,1] neg_hi:[0,0,1]
    v_pk_fma_f32 v[26:27], v[34:35], v[14:15], v[26:27] op_sel:[0,0,0] op_sel_hi:[1,0,1] neg_lo:[0,0,1] neg_hi:[0,0,1]
    v_pk_fma_f32 v[28:29], v[36:37], v[14:15], v[28:29] op_sel:[0,0,0] op_sel_hi:[1,0,1] neg_lo:[0,0,1] neg_hi:[0,0,1]
    v_pk_fma_f32 v[30:31], v[38:39], v[14:15], v[30:31] op_sel:[0,0,0] op_sel_hi:[1,0,1] neg_lo:[0,0,1] neg_hi:[0,0,1]
    v_cvt_pk_bf16_f32 v168, v24, v25
    v_cvt_pk_bf16_f32 v169, v26, v27
    v_cvt_pk_bf16_f32 v170, v28, v29
    v_cvt_pk_bf16_f32 v171, v30, v31
    v_pk_fma_f32 v[32:33], v[24:25], v[14:15], v[32:33] op_sel:[0,0,0] op_sel_hi:[1,0,1] neg_lo:[0,0,1] neg_hi:[0,0,1]
    v_pk_fma_f32 v[34:35], v[26:27], v[14:15], v[34:35] op_sel:[0,0,0] op_sel_hi:[1,0,1] neg_lo:[0,0,1] neg_hi:[0,0,1]
    v_pk_fma_f32 v[36:37], v[28:29], v[14:15], v[36:37] op_sel:[0,0,0] op_sel_hi:[1,0,1] neg_lo:[0,0,1] neg_hi:[0,0,1]
    v_pk_fma_f32 v[38:39], v[30:31], v[14:15], v[38:39] op_sel:[0,0,0] op_sel_hi:[1,0,1] neg_lo:[0,0,1] neg_hi:[0,0,1]
    v_cvt_pk_bf16_f32 v172, v32, v33
    v_cvt_pk_bf16_f32 v173, v34, v35
    v_cvt_pk_bf16_f32 v174, v36, v37
    v_cvt_pk_bf16_f32 v175, v38, v39
    v_pk_fma_f32 v[24:25], v[32:33], v[14:15], v[24:25] op_sel:[0,0,0] op_sel_hi:[1,0,1] neg_lo:[0,0,1] neg_hi:[0,0,1]
    v_pk_fma_f32 v[26:27], v[34:35], v[14:15], v[26:27] op_sel:[0,0,0] op_sel_hi:[1,0,1] neg_lo:[0,0,1] neg_hi:[0,0,1]
    v_pk_fma_f32 v[28:29], v[36:37], v[14:15], v[28:29] op_sel:[0,0,0] op_sel_hi:[1,0,1] neg_lo:[0,0,1] neg_hi:[0,0,1]
    v_pk_fma_f32 v[30:31], v[38:39], v[14:15], v[30:31] op_sel:[0,0,0] op_sel_hi:[1,0,1] neg_lo:[0,0,1] neg_hi:[0,0,1]
    v_cvt_pk_bf16_f32 v176, v24, v25
    v_cvt_pk_bf16_f32 v177, v26, v27
    v_cvt_pk_bf16_f32 v178, v28, v29
    v_cvt_pk_bf16_f32 v179, v30, v31
    v_pk_fma_f32 v[32:33], v[24:25], v[14:15], v[32:33] op_sel:[0,0,0] op_sel_hi:[1,0,1] neg_lo:[0,0,1] neg_hi:[0,0,1]
    v_pk_fma_f32 v[34:35], v[26:27], v[14:15], v[34:35] op_sel:[0,0,0] op_sel_hi:[1,0,1] neg_lo:[0,0,1] neg_hi:[0,0,1]
    v_pk_fma_f32 v[36:37], v[28:29], v[14:15], v[36:37] op_sel:[0,0,0] op_sel_hi:[1,0,1] neg_lo:[0,0,1] neg_hi:[0,0,1]
    v_pk_fma_f32 v[38:39], v[30:31], v[14:15], v[38:39] op_sel:[0,0,0] op_sel_hi:[1,0,1] neg_lo:[0,0,1] neg_hi:[0,0,1]
    v_cvt_pk_bf16_f32 v180, v32, v33
    v_cvt_pk_bf16_f32 v181, v34, v35
    v_cvt_pk_bf16_f32 v182, v36, v37
    v_cvt_pk_bf16_f32 v183, v38, v39
    v_bfe_u32 v2, v1, 2, 2
    v_lshl_add_u32 v2, v10, 2, v2
    v_lshlrev_b32 v2, 6, v2
    v_bfe_u32 v3, v1, 4, 1
    v_lshl_add_u32 v2, v3, 5, v2
    v_and_b32 v3, 3, v1
    v_lshl_add_u32 v13, v3, 3, v2
    s_waitcnt vmcnt(2)
    s_barrier
    ds_read_b64_tr_b16 v[56:57], v13 offset:0
    ds_read_b64_tr_b16 v[58:59], v13 offset:512
    ds_read_b64_tr_b16 v[60:61], v13 offset:1024
    ds_read_b64_tr_b16 v[62:63], v13 offset:1536
    ds_read_b64_tr_b16 v[64:65], v13 offset:2048
    ds_read_b64_tr_b16 v[66:67], v13 offset:2560
    s_waitcnt lgkmcnt(4)
    v_mfma_f32_32x32x16_bf16 v[40:55], v[72:75], v[56:59], 0
    ds_read_b64_tr_b16 v[68:69], v13 offset:3072
    ds_read_b64_tr_b16 v[70:71], v13 offset:3584
    s_waitcnt lgkmcnt(4)
    v_mfma_f32_32x32x16_bf16 v[40:55], v[76:79], v[60:63], v[40:55]
    ds_read_b64_tr_b16 v[56:57], v13 offset:4096
    ds_read_b64_tr_b16 v[58:59], v13 offset:4608
    s_waitcnt lgkmcnt(4)
    v_mfma_f32_32x32x16_bf16 v[40:55], v[80:83], v[64:67], v[40:55]
    ds_read_b64_tr_b16 v[60:61], v13 offset:5120
    ds_read_b64_tr_b16 v[62:63], v13 offset:5632
    s_waitcnt lgkmcnt(4)
    v_mfma_f32_32x32x16_bf16 v[40:55], v[84:87], v[68:71], v[40:55]
    ds_read_b64_tr_b16 v[64:65], v13 offset:6144
    ds_read_b64_tr_b16 v[66:67], v13 offset:6656
    s_waitcnt lgkmcnt(4)
    v_mfma_f32_32x32x16_bf16 v[40:55], v[88:91], v[56:59], v[40:55]
    ds_read_b64_tr_b16 v[68:69], v13 offset:7168
    ds_read_b64_tr_b16 v[70:71], v13 offset:7680
    s_waitcnt lgkmcnt(4)
    v_mfma_f32_32x32x16_bf16 v[40:55], v[92:95], v[60:63], v[40:55]
    ds_read_b64_tr_b16 v[56:57], v13 offset:8192
    ds_read_b64_tr_b16 v[58:59], v13 offset:8704
    s_waitcnt lgkmcnt(4)
    v_mfma_f32_32x32x16_bf16 v[40:55], v[96:99], v[64:67], v[40:55]
    ds_read_b64_tr_b16 v[60:61], v13 offset:9216
    ds_read_b64_tr_b16 v[62:63], v13 offset:9728
    s_waitcnt lgkmcnt(4)
    v_mfma_f32_32x32x16_bf16 v[40:55], v[100:103], v[68:71], v[40:55]
    ds_read_b64_tr_b16 v[64:65], v13 offset:10240
    ds_read_b64_tr_b16 v[66:67], v13 offset:10752
    s_waitcnt lgkmcnt(4)
    v_mfma_f32_32x32x16_bf16 v[40:55], v[104:107], v[56:59], v[40:55]
    ds_read_b64_tr_b16 v[68:69], v13 offset:11264
    ds_read_b64_tr_b16 v[70:71], v13 offset:11776
    s_waitcnt lgkmcnt(4)
    v_mfma_f32_32x32x16_bf16 v[40:55], v[108:111], v[60:63], v[40:55]
    ds_read_b64_tr_b16 v[56:57], v13 offset:12288
    ds_read_b64_tr_b16 v[58:59], v13 offset:12800
    s_waitcnt lgkmcnt(4)
    v_mfma_f32_32x32x16_bf16 v[40:55], v[112:115], v[64:67], v[40:55]
    ds_read_b64_tr_b16 v[60:61], v13 offset:13312
    ds_read_b64_tr_b16 v[62:63], v13 offset:13824
    s_waitcnt lgkmcnt(4)
    v_mfma_f32_32x32x16_bf16 v[40:55], v[116:119], v[68:71], v[40:55]
    ds_read_b64_tr_b16 v[64:65], v13 offset:14336
    ds_read_b64_tr_b16 v[66:67], v13 offset:14848
    s_waitcnt lgkmcnt(4)
    v_mfma_f32_32x32x16_bf16 v[40:55], v[120:123], v[56:59], v[40:55]
    ds_read_b64_tr_b16 v[68:69], v13 offset:15360
    ds_read_b64_tr_b16 v[70:71], v13 offset:15872
    s_waitcnt lgkmcnt(4)
    v_mfma_f32_32x32x16_bf16 v[40:55], v[124:127], v[60:63], v[40:55]
    ds_read_b64_tr_b16 v[56:57], v13 offset:16384
    ds_read_b64_tr_b16 v[58:59], v13 offset:16896
    s_waitcnt lgkmcnt(4)
    v_mfma_f32_32x32x16_bf16 v[40:55], v[128:131], v[64:67], v[40:55]
    ds_read_b64_tr_b16 v[60:61], v13 offset:17408
    ds_read_b64_tr_b16 v[62:63], v13 offset:17920
    s_waitcnt lgkmcnt(4)
    v_mfma_f32_32x32x16_bf16 v[40:55], v[132:135], v[68:71], v[40:55]
    ds_read_b64_tr_b16 v[64:65], v13 offset:18432
    ds_read_b64_tr_b16 v[66:67], v13 offset:18944
    s_waitcnt lgkmcnt(4)
    v_mfma_f32_32x32x16_bf16 v[40:55], v[136:139], v[56:59], v[40:55]
    ds_read_b64_tr_b16 v[68:69], v13 offset:19456
    ds_read_b64_tr_b16 v[70:71], v13 offset:19968
    s_waitcnt lgkmcnt(4)
    v_mfma_f32_32x32x16_bf16 v[40:55], v[140:143], v[60:63], v[40:55]
    s_waitcnt vmcnt(0)
    s_barrier
    ds_read_b64_tr_b16 v[56:57], v13 offset:20480
    ds_read_b64_tr_b16 v[58:59], v13 offset:20992
    s_waitcnt lgkmcnt(4)
    v_mfma_f32_32x32x16_bf16 v[40:55], v[144:147], v[64:67], v[40:55]
    ds_read_b64_tr_b16 v[60:61], v13 offset:21504
    ds_read_b64_tr_b16 v[62:63], v13 offset:22016
    s_waitcnt lgkmcnt(4)
    v_mfma_f32_32x32x16_bf16 v[40:55], v[148:151], v[68:71], v[40:55]
    ds_read_b64_tr_b16 v[64:65], v13 offset:22528
    ds_read_b64_tr_b16 v[66:67], v13 offset:23040
    s_waitcnt lgkmcnt(4)
    v_mfma_f32_32x32x16_bf16 v[40:55], v[152:155], v[56:59], v[40:55]
    ds_read_b64_tr_b16 v[68:69], v13 offset:23552
    ds_read_b64_tr_b16 v[70:71], v13 offset:24064
    s_waitcnt lgkmcnt(4)
    v_mfma_f32_32x32x16_bf16 v[40:55], v[156:159], v[60:63], v[40:55]
    ds_read_b64_tr_b16 v[56:57], v13 offset:24576
    ds_read_b64_tr_b16 v[58:59], v13 offset:25088
    s_waitcnt lgkmcnt(4)
    v_mfma_f32_32x32x16_bf16 v[40:55], v[160:163], v[64:67], v[40:55]
    ds_read_b64_tr_b16 v[60:61], v13 offset:25600
    ds_read_b64_tr_b16 v[62:63], v13 offset:26112
    s_waitcnt lgkmcnt(4)
    v_mfma_f32_32x32x16_bf16 v[40:55], v[164:167], v[68:71], v[40:55]
    ds_read_b64_tr_b16 v[64:65], v13 offset:26624
    ds_read_b64_tr_b16 v[66:67], v13 offset:27136
    s_waitcnt lgkmcnt(4)
    v_mfma_f32_32x32x16_bf16 v[40:55], v[168:171], v[56:59], v[40:55]
    ds_read_b64_tr_b16 v[68:69], v13 offset:27648
    ds_read_b64_tr_b16 v[70:71], v13 offset:28160
    s_waitcnt lgkmcnt(4)
    v_mfma_f32_32x32x16_bf16 v[40:55], v[172:175], v[60:63], v[40:55]
    s_waitcnt lgkmcnt(2)
    v_mfma_f32_32x32x16_bf16 v[40:55], v[176:179], v[64:67], v[40:55]
    s_waitcnt lgkmcnt(0)
    v_mfma_f32_32x32x16_bf16 v[40:55], v[180:183], v[68:71], v[40:55]
    s_nop 11
    ds_write_b128 v12, v[40:43] offset:0
    ds_write_b128 v12, v[44:47] offset:1024
    ds_write_b128 v12, v[48:51] offset:2048
    ds_write_b128 v12, v[52:55] offset:3072
    s_waitcnt lgkmcnt(0)
    s_barrier
    s_endpgm
k3_epi:
    v_mul_u32_u24 v8, 28672, v2
    v_lshlrev_b32 v9, 4, v10
    v_add_u32 v8, v8, v9
    s_mul_i32 s61, s61, 112
    s_add_u32 s61, s61, s9
    s_lshl_b32 s61, s61, 11
    s_add_u32 s61, s61, 114688
    s_lshl_b32 s10, s9, 6
    s_lshl_b32 s59, s5, 10
    s_add_u32 s59, s59, s8
    s_mul_i32 s59, s59, 896
    s_add_u32 s59, s59, s10
    s_mov_b32 s14, 0x36124925
    s_mov_b32 s15, 0xffff0000
    s_add_u32 s58, s59, 27262976
    s_mov_b32 s62, 0x3f80
    s_mov_b32 s63, 0x3f800000
    s_waitcnt lgkmcnt(0)
    s_mov_b32 s44, s34
    s_and_b32 s45, s35, 0xffff
    s_mov_b32 s46, 268435456
    s_mov_b32 s47, 0x00020000
    s_mov_b32 s36, s16
    s_and_b32 s37, s17, 0xffff
    s_mov_b32 s38, 1835008
    s_mov_b32 s39, 0x00020000
    s_load_dwordx16 s[16:31], s[30:31], s10
    s_sleep 4
    buffer_load_dwordx4 v[88:91], v8, s[36:39], s59 offen offset:0
    buffer_load_dwordx4 v[92:95], v8, s[36:39], s59 offen offset:32
    buffer_load_dwordx4 v[56:59], v6, s[44:47], s61 offen offset:0
    buffer_load_dwordx4 v[60:63], v6, s[44:47], s61 offen offset:1024
    s_add_u32 s61, s61, 28672
    buffer_load_dwordx4 v[64:67], v6, s[44:47], s61 offen offset:0
    buffer_load_dwordx4 v[68:71], v6, s[44:47], s61 offen offset:1024
    s_add_u32 s61, s61, 28672
    buffer_load_dwordx4 v[72:75], v6, s[44:47], s61 offen offset:0
    buffer_load_dwordx4 v[76:79], v6, s[44:47], s61 offen offset:1024
    s_add_u32 s61, s61, 28672
    buffer_load_dwordx4 v[80:83], v6, s[44:47], s61 offen offset:0
    buffer_load_dwordx4 v[84:87], v6, s[44:47], s61 offen offset:1024
    s_mov_b32 s52, s32
    s_and_b32 s53, s33, 0xffff
    s_mov_b32 s54, 1835008
    s_mov_b32 s55, 0x00020000
    s_waitcnt lgkmcnt(0)
    v_mov_b32 v96, s16
    v_mov_b32 v97, s17
    v_mov_b32 v98, s20
    v_mov_b32 v99, s21
    v_mov_b32 v100, s24
    v_mov_b32 v101, s25
    v_mov_b32 v102, s28
    v_mov_b32 v103, s29
    s_mov_b32 exec_lo, 0
    v_mov_b32 v96, s18
    v_mov_b32 v97, s19
    v_mov_b32 v98, s22
    v_mov_b32 v99, s23
    v_mov_b32 v100, s26
    v_mov_b32 v101, s27
    v_mov_b32 v102, s30
    v_mov_b32 v103, s31
    s_mov_b32 exec_lo, -1
    s_barrier
    s_barrier
    s_waitcnt vmcnt(8)
    v_permlane32_swap_b32 v88, v90
    v_permlane32_swap_b32 v89, v91
    v_permlane32_swap_b32 v92, v94
    v_permlane32_swap_b32 v93, v95
    v_lshlrev_b32 v104, 16, v88
    v_and_b32 v105, s15, v88
    v_lshlrev_b32 v106, 16, v89
    v_and_b32 v107, s15, v89
    v_lshlrev_b32 v108, 16, v90
    v_and_b32 v109, s15, v90
    v_lshlrev_b32 v110, 16, v91
    v_and_b32 v111, s15, v91
    v_lshlrev_b32 v112, 16, v92
    v_and_b32 v113, s15, v92
    v_lshlrev_b32 v114, 16, v93
    v_and_b32 v115, s15, v93
    v_lshlrev_b32 v116, 16, v94
    v_and_b32 v117, s15, v94
    v_lshlrev_b32 v118, 16, v95
    v_and_b32 v119, s15, v95
    v_dot2c_f32_bf16 v104, s62, v96
    v_dot2c_f32_bf16 v105, s63, v96
    v_dot2c_f32_bf16 v106, s62, v97
    v_dot2c_f32_bf16 v107, s63, v97
    v_dot2c_f32_bf16 v108, s62, v98
    v_dot2c_f32_bf16 v109, s63, v98
    v_dot2c_f32_bf16 v110, s62, v99
    v_dot2c_f32_bf16 v111, s63, v99
    v_dot2c_f32_bf16 v112, s62, v100
    v_dot2c_f32_bf16 v113, s63, v100
    v_dot2c_f32_bf16 v114, s62, v101
    v_dot2c_f32_bf16 v115, s63, v101
    v_dot2c_f32_bf16 v116, s62, v102
    v_dot2c_f32_bf16 v117, s63, v102
    v_dot2c_f32_bf16 v118, s62, v103
    v_dot2c_f32_bf16 v119, s63, v103
    s_waitcnt vmcnt(6)
    v_dot2c_f32_bf16 v104, s62, v56
    v_dot2c_f32_bf16 v105, s63, v56
    v_dot2c_f32_bf16 v106, s62, v57
    v_dot2c_f32_bf16 v107, s63, v57
    v_dot2c_f32_bf16 v108, s62, v58
    v_dot2c_f32_bf16 v109, s63, v58
    v_dot2c_f32_bf16 v110, s62, v59
    v_dot2c_f32_bf16 v111, s63, v59
    v_dot2c_f32_bf16 v112, s62, v60
    v_dot2c_f32_bf16 v113, s63, v60
    v_dot2c_f32_bf16 v114, s62, v61
    v_dot2c_f32_bf16 v115, s63, v61
    v_dot2c_f32_bf16 v116, s62, v62
    v_dot2c_f32_bf16 v117, s63, v62
    v_dot2c_f32_bf16 v118, s62, v63
    v_dot2c_f32_bf16 v119, s63, v63
    s_waitcnt vmcnt(4)
    v_dot2c_f32_bf16 v104, s62, v64
    v_dot2c_f32_bf16 v105, s63, v64
    v_dot2c_f32_bf16 v106, s62, v65
    v_dot2c_f32_bf16 v107, s63, v65
    v_dot2c_f32_bf16 v108, s62, v66
    v_dot2c_f32_bf16 v109, s63, v66
    v_dot2c_f32_bf16 v110, s62, v67
    v_dot2c_f32_bf16 v111, s63, v67
    v_dot2c_f32_bf16 v112, s62, v68
    v_dot2c_f32_bf16 v113, s63, v68
    v_dot2c_f32_bf16 v114, s62, v69
    v_dot2c_f32_bf16 v115, s63, v69
    v_dot2c_f32_bf16 v116, s62, v70
    v_dot2c_f32_bf16 v117, s63, v70
    v_dot2c_f32_bf16 v118, s62, v71
    v_dot2c_f32_bf16 v119, s63, v71
    s_waitcnt vmcnt(2)
    v_dot2c_f32_bf16 v104, s62, v72
    v_dot2c_f32_bf16 v105, s63, v72
    v_dot2c_f32_bf16 v106, s62, v73
    v_dot2c_f32_bf16 v107, s63, v73
    v_dot2c_f32_bf16 v108, s62, v74
    v_dot2c_f32_bf16 v109, s63, v74
    v_dot2c_f32_bf16 v110, s62, v75
    v_dot2c_f32_bf16 v111, s63, v75
    v_dot2c_f32_bf16 v112, s62, v76
    v_dot2c_f32_bf16 v113, s63, v76
    v_dot2c_f32_bf16 v114, s62, v77
    v_dot2c_f32_bf16 v115, s63, v77
    v_dot2c_f32_bf16 v116, s62, v78
    v_dot2c_f32_bf16 v117, s63, v78
    v_dot2c_f32_bf16 v118, s62, v79
    v_dot2c_f32_bf16 v119, s63, v79
    s_waitcnt vmcnt(0)
    v_dot2c_f32_bf16 v104, s62, v80
    v_dot2c_f32_bf16 v105, s63, v80
    v_dot2c_f32_bf16 v106, s62, v81
    v_dot2c_f32_bf16 v107, s63, v81
    v_dot2c_f32_bf16 v108, s62, v82
    v_dot2c_f32_bf16 v109, s63, v82
    v_dot2c_f32_bf16 v110, s62, v83
    v_dot2c_f32_bf16 v111, s63, v83
    v_dot2c_f32_bf16 v112, s62, v84
    v_dot2c_f32_bf16 v113, s63, v84
    v_dot2c_f32_bf16 v114, s62, v85
    v_dot2c_f32_bf16 v115, s63, v85
    v_dot2c_f32_bf16 v116, s62, v86
    v_dot2c_f32_bf16 v117, s63, v86
    v_dot2c_f32_bf16 v118, s62, v87
    v_dot2c_f32_bf16 v119, s63, v87
    s_barrier
    ds_read_b128 v[40:43], v12 offset:0
    ds_read_b128 v[44:47], v12 offset:1024
    ds_read_b128 v[48:51], v12 offset:2048
    ds_read_b128 v[52:55], v12 offset:3072
    s_waitcnt lgkmcnt(3)
    v_fma_f32 v104, v40, s14, v104
    v_fma_f32 v105, v41, s14, v105
    v_fma_f32 v106, v42, s14, v106
    v_fma_f32 v107, v43, s14, v107
    s_waitcnt lgkmcnt(2)
    v_fma_f32 v108, v44, s14, v108
    v_fma_f32 v109, v45, s14, v109
    v_fma_f32 v110, v46, s14, v110
    v_fma_f32 v111, v47, s14, v111
    v_cvt_pk_bf16_f32 v88, v104, v105
    v_cvt_pk_bf16_f32 v89, v106, v107
    v_cvt_pk_bf16_f32 v90, v108, v109
    v_cvt_pk_bf16_f32 v91, v110, v111
    s_nop 0
    v_permlane32_swap_b32 v88, v90
    v_permlane32_swap_b32 v89, v91
    buffer_store_dwordx4 v[88:91], v8, s[52:55], s59 offen offset:0
    s_waitcnt lgkmcnt(1)
    v_fma_f32 v112, v48, s14, v112
    v_fma_f32 v113, v49, s14, v113
    v_fma_f32 v114, v50, s14, v114
    v_fma_f32 v115, v51, s14, v115
    s_waitcnt lgkmcnt(0)
    v_fma_f32 v116, v52, s14, v116
    v_fma_f32 v117, v53, s14, v117
    v_fma_f32 v118, v54, s14, v118
    v_fma_f32 v119, v55, s14, v119
    v_cvt_pk_bf16_f32 v92, v112, v113
    v_cvt_pk_bf16_f32 v93, v114, v115
    v_cvt_pk_bf16_f32 v94, v116, v117
    v_cvt_pk_bf16_f32 v95, v118, v119
    s_nop 0
    v_permlane32_swap_b32 v92, v94
    v_permlane32_swap_b32 v93, v95
    buffer_store_dwordx4 v[92:95], v8, s[52:55], s59 offen offset:32
    s_endpgm
k3_kernel_end:
    s_endpgm
code_end:
.section .rodata,"a"
.p2align 6
.amdhsa_kernel k1_kernel
  .amdhsa_next_free_vgpr 252
  .amdhsa_next_free_sgpr 102
  .amdhsa_accum_offset 252
  .amdhsa_group_segment_fixed_size 0
  .amdhsa_kernarg_size 88
  .amdhsa_user_sgpr_count 2
  .amdhsa_user_sgpr_kernarg_segment_ptr 1
  .amdhsa_system_sgpr_workgroup_id_x 1
.end_amdhsa_kernel
.p2align 6
.amdhsa_kernel k2_kernel
  .amdhsa_next_free_vgpr 232
  .amdhsa_next_free_sgpr 102
  .amdhsa_accum_offset 232
  .amdhsa_group_segment_fixed_size 0
  .amdhsa_kernarg_size 88
  .amdhsa_user_sgpr_count 2
  .amdhsa_user_sgpr_kernarg_segment_ptr 1
  .amdhsa_system_sgpr_workgroup_id_x 1
.end_amdhsa_kernel
.p2align 6
.amdhsa_kernel k3_kernel
  .amdhsa_next_free_vgpr 192
  .amdhsa_next_free_sgpr 102
  .amdhsa_accum_offset 192
  .amdhsa_group_segment_fixed_size 0
  .amdhsa_kernarg_size 88
  .amdhsa_user_sgpr_count 2
  .amdhsa_user_sgpr_kernarg_segment_ptr 1
  .amdhsa_system_sgpr_workgroup_id_x 1
.end_amdhsa_kernel
```
